```python
import torch

def _softmax(x, axis=-1):
    return torch.softmax(x, dim=axis)
def _gelu(x):
    return torch.nn.functional.gelu(x, approximate="tanh")
def _silu(x):
    return torch.nn.functional.silu(x)
def _sigmoid(x):
    return torch.sigmoid(x)
def _layernorm(x, axis=-1, eps=1e-5):
    m = x.mean(dim=axis, keepdim=True)
    v = x.var(dim=axis, keepdim=True, unbiased=False)
    return (x - m) / torch.sqrt(v + eps)
def _scatter_add(tgt, idx, src, axis=0):
    return tgt.clone().index_add_(axis, idx, src)
def _segment_sum(src, seg, n):
    out = torch.zeros((n,) + src.shape[1:], dtype=src.dtype)
    return out.index_add_(0, seg, src)
def _pad(x, pw):
    flat = tuple(v for pair in reversed(pw) for v in pair)
    return torch.nn.functional.pad(x, flat)

kernel_name = 'parallel_sum__ssm_conv_s5__dense_activation_squared_relu__prompt'

def setup_inputs():

    _w = (lambda a: (lambda t: t.to(torch.bfloat16) if t.is_floating_point() else t)(torch.as_tensor(a)))
    def _A_setup():
        B, S, D = 1, 2048, 640
        P = D
        Lambda_re = -0.5 * (lambda _x: torch.exp(torch.as_tensor(_x)))((lambda *s: torch.randn(*s, dtype=torch.bfloat16) * 0.8)(P))
        Lambda_im = (lambda *s: torch.randn(*s, dtype=torch.bfloat16) * 0.8)(P) * 1.0
        B_re = (lambda *s: torch.randn(*s, dtype=torch.bfloat16) * 1.6)(P, D) * (D ** -0.5)
        B_im = (lambda *s: torch.randn(*s, dtype=torch.bfloat16) * 1.6)(P, D) * (D ** -0.5)
        C_re = (lambda *s: torch.randn(*s, dtype=torch.bfloat16) * 1.6)(D, P) * (P ** -0.5)
        C_im = (lambda *s: torch.randn(*s, dtype=torch.bfloat16) * 1.6)(D, P) * (P ** -0.5)
        log_dt = (lambda *s: torch.randn(*s, dtype=torch.bfloat16) * 0.8)(P) * 0.3 - 2.0
        Dskip = (lambda *s: torch.randn(*s, dtype=torch.bfloat16) * 0.8)(D)
        return {
            "x": _w((lambda *s: torch.randn(*s, dtype=torch.bfloat16) * 0.05)(B, S, D)),
            "Lambda_re": _w(Lambda_re),
            "Lambda_im": _w(Lambda_im),
            "B_re": _w(B_re),
            "B_im": _w(B_im),
            "C_re": _w(C_re),
            "C_im": _w(C_im),
            "log_dt": _w(log_dt),
            "Dskip": _w(Dskip),
        }
    _A_in = _A_setup()

    def _B_setup():
        B, S, D, F = 1, 2048, 640, 1728
        return {
            "x": _w((lambda *s: torch.randn(*s, dtype=torch.bfloat16) * 0.05)(B, S, D)),
            "w1": _w((lambda *s: torch.randn(*s, dtype=torch.bfloat16) * 0.05)(D, F)),
            "b1": _w((lambda *s: torch.randn(*s, dtype=torch.bfloat16) * 0.4)(F)),
            "w2": _w((lambda *s: torch.randn(*s, dtype=torch.bfloat16) * 0.05)(F, D)),
            "b2": _w((lambda *s: torch.randn(*s, dtype=torch.bfloat16) * 1.6)(D)),
        }
    _B_in = _B_setup()

    return {
        "A_x": _A_in["x"],
        "A_Lambda_re": _A_in["Lambda_re"],
        "A_Lambda_im": _A_in["Lambda_im"],
        "A_B_re": _A_in["B_re"],
        "A_B_im": _A_in["B_im"],
        "A_C_re": _A_in["C_re"],
        "A_C_im": _A_in["C_im"],
        "A_log_dt": _A_in["log_dt"],
        "A_Dskip": _A_in["Dskip"],
        "B_x": _B_in["x"],
        "B_w1": _B_in["w1"],
        "B_b1": _B_in["b1"],
        "B_w2": _B_in["w2"],
        "B_b2": _B_in["b2"],
    }

def reference(A_x, A_Lambda_re, A_Lambda_im, A_B_re, A_B_im, A_C_re, A_C_im, A_log_dt, A_Dskip, B_x, B_w1, B_b1, B_w2, B_b2):
    def _A_ref(x, Lambda_re, Lambda_im, B_re, B_im, C_re, C_im, log_dt, Dskip):
        Bsz, L, H = x.shape
        Lam = Lambda_re + 1j * Lambda_im
        Bmat = B_re + 1j * B_im
        Cmat = C_re + 1j * C_im
        dt = torch.exp(log_dt)
        Lam_bar = torch.exp(dt * Lam)
        B_bar = ((Lam_bar - 1.0) / Lam)[:, None] * Bmat
        Bu = torch.einsum("bld,pd->blp", x + 0j, B_bar)
        h = torch.zeros_like(Bu[:, 0, :])
        hs = []
        for t in range(L):
            h = Lam_bar[None, :] * h + Bu[:, t, :]
            hs.append(h)
        hseq = torch.stack(hs, 1)
        y = 2.0 * torch.einsum("blp,dp->bld", hseq, Cmat).real + x * Dskip[None, None, :]
        return y

    def _B_ref(x, w1, b1, w2, b2):
        h = torch.einsum("bsd,df->bsf", x, w1) + b1
        zero = torch.zeros_like(h)
        r = torch.where(h > zero, h, zero)
        h = r * r
        out = torch.einsum("bsf,fd->bsd", h, w2) + b2
        return out

    x = A_x
    xn = _layernorm(x, axis=-1)
    return x + _A_ref(xn, A_Lambda_re, A_Lambda_im, A_B_re, A_B_im, A_C_re, A_C_im, A_log_dt, A_Dskip) + _B_ref(xn, B_w1, B_b1, B_w2, B_b2)
```

```asm
; @launch grid=(256,1,1) block=(512,1,1) lds=163840
.amdgcn_target "amdgcn-amd-amdhsa--gfx950"
.text
.p2align 12
.text
.globl parallel_sum__ssm_conv_s5__dense_activation_squared_relu__prompt_kernel
.p2align 8
.type parallel_sum__ssm_conv_s5__dense_activation_squared_relu__prompt_kernel,@function
parallel_sum__ssm_conv_s5__dense_activation_squared_relu__prompt_kernel:
    s_cmp_ge_u32 s2, 256
    s_cbranch_scc1 L_exit
    s_load_dwordx16 s[8:23], s[0:1], 0
    s_load_dwordx16 s[24:39], s[0:1], 64
    s_load_dwordx2 s[40:41], s[0:1], 128
    v_lshrrev_b32 v1, 6, v0
    s_lshr_b32 s55, s2, 3
    v_readfirstlane_b32 s3, v1
    s_cmp_ge_u32 s3, 4
    s_cbranch_scc1 L_helper
    v_and_b32 v0, 63, v0
    s_and_b32 s53, s2, 1
    s_bfe_u32 s54, s2, 0x20001
    s_and_b32 s49, s55, 7
    s_lshr_b32 s4, s55, 3
    s_lshl2_add_u32 s42, s54, s4
    s_lshl3_add_u32 s43, s53, s49
    s_and_b32 s52, s3, 3
    v_and_b32 v1, 15, v0
    v_lshrrev_b32 v2, 4, v0
    v_lshrrev_b32 v68, 3, v0
    v_and_b32_e64 v69, 7, v0
    s_mov_b32 s79, 0x20000
    s_cmp_eq_u32 s52, 1
    s_cbranch_scc1 L_r1_1
    s_cmp_eq_u32 s52, 2
    s_cbranch_scc1 L_r2_2
    s_lshl4_add_u32 s4, s42, s43
    s_lshr_b32 s5, s52, 1
    s_lshl1_add_u32 s4, s4, s5
    s_mul_i32 s7, s4, 5120
    s_lshl_b32 s84, s4, 7
    s_add_u32 s84, s84, 0x28000
    s_movk_i32 s85, 256
    s_mov_b32 s78, 0x280000
    v_mul_u32_u24 v76, 1280, v2
    v_lshl_add_u32 v76, v1, 4, v76
    v_lshl_add_u32 v77, v2, 2, v1
    s_waitcnt lgkmcnt(0)
    s_mov_b64 s[76:77], s[8:9]
    s_branch L_re_3
L_r1_1:
    s_lshl2_add_u32 s4, s55, s54
    s_cmp_lt_u32 s4, 80
    s_cselect_b32 s78, 0xc8000, 0
    s_mul_i32 s5, s53, 40
    s_add_u32 s5, s5, s4
    s_movk_i32 s85, 128
    v_mul_u32_u24 v76, 1280, v68
    v_lshl_add_u32 v76, v69, 4, v76
    v_lshl_add_u32 v77, v68, 1, v69
    s_cmp_ge_u32 s4, 40
    s_cselect_b32 s6, 40, 0
    s_waitcnt lgkmcnt(0)
    s_cselect_b64 s[76:77], s[16:17], s[14:15]
    s_sub_u32 s4, s5, s6
    s_mul_i32 s7, s4, 10240
    s_add_u32 s5, s5, s6
    s_lshl_b32 s84, s5, 7
    s_add_u32 s84, s84, 0x38000
    s_branch L_re_3
L_r2_2:
    s_sub_u32 s4, 31, s55
    s_lshl2_add_u32 s4, s4, s54
    s_mul_i32 s6, s53, 112
    s_add_u32 s6, s6, s4
    s_cmp_lt_u32 s4, 112
    s_cselect_b32 s78, 0x21c000, 0
    s_cmp_lt_u32 s6, 216
    s_cselect_b32 s78, s78, 0
    s_lshl_b32 s84, s6, 9
    s_add_u32 s84, s84, 0x3d000
    s_movk_i32 s85, 27648
    s_and_b32 s4, s6, 7
    s_mul_i32 s7, s4, 276480
    s_lshr_b32 s5, s6, 3
    s_lshl_b32 s5, s5, 7
    s_add_u32 s7, s7, s5
    v_mul_u32_u24 v76, 3456, v68
    v_lshl_add_u32 v76, v69, 4, v76
    v_lshl_add_u32 v77, v69, 3, v68
    s_waitcnt lgkmcnt(0)
    s_mov_b64 s[76:77], s[28:29]
L_re_3:
    buffer_load_dwordx4 v[80:83], v76, s[76:79], s7 offen
    s_add_u32 s7, s7, s85
    buffer_load_dwordx4 v[84:87], v76, s[76:79], s7 offen
    s_add_u32 s7, s7, s85
    buffer_load_dwordx4 v[88:91], v76, s[76:79], s7 offen
    s_add_u32 s7, s7, s85
    buffer_load_dwordx4 v[92:95], v76, s[76:79], s7 offen
    s_add_u32 s7, s7, s85
    buffer_load_dwordx4 v[96:99], v76, s[76:79], s7 offen
    s_add_u32 s7, s7, s85
    s_cmp_eq_u32 s85, 0x100
    s_cbranch_scc1 L_compute
    buffer_load_dwordx4 v[100:103], v76, s[76:79], s7 offen
    s_add_u32 s7, s7, s85
    buffer_load_dwordx4 v[104:107], v76, s[76:79], s7 offen
    s_add_u32 s7, s7, s85
    buffer_load_dwordx4 v[108:111], v76, s[76:79], s7 offen
    s_add_u32 s7, s7, s85
    buffer_load_dwordx4 v[112:115], v76, s[76:79], s7 offen
    s_add_u32 s7, s7, s85
    buffer_load_dwordx4 v[116:119], v76, s[76:79], s7 offen
    s_add_u32 s7, s7, s85
    s_branch L_compute
L_helper:
    v_and_b32 v0, 63, v0
    s_and_b32 s53, s2, 1
    s_bfe_u32 s54, s2, 0x20001
    s_and_b32 s49, s55, 7
    s_lshr_b32 s4, s55, 3
    s_lshl2_add_u32 s42, s54, s4
    s_lshl3_add_u32 s43, s53, s49
    s_and_b32 s52, s3, 3
    s_lshl1_add_u32 s50, s42, s53
    s_mul_i32 s5, s53, 10
    s_mul_i32 s6, s53, 14
    s_add_u32 s47, s6, s49
    s_add_u32 s5, s5, s49
    s_min_u32 s4, s49, 2
    s_add_u32 s45, s5, s4
    s_add_u32 s4, s45, 1
    s_add_u32 s5, s47, 6
    s_cmp_lt_u32 s49, 2
    s_cselect_b32 s44, 1, 0
    s_cselect_b32 s46, s4, s5
    s_min_u32 s48, s46, 26
    v_lshrrev_b32 v1, 3, v0
    v_and_b32 v2, 7, v0
    v_lshrrev_b32 v3, 4, v0
    v_xor_b32 v4, v2, v3
    v_lshlrev_b32 v4, 4, v4
    v_lshrrev_b32 v20, 5, v0
    v_and_b32_e64 v21, 3, v1
    v_lshl_add_u32 v20, v20, 4, v21
    v_mul_u32_u24 v20, 1280, v20
    v_add_u32 v5, v20, v4
    v_xor_b32 v21, 64, v5
    v_add_u32 v6, 40960, v21
    v_add_u32 v7, 5120, v5
    v_add_u32 v8, 5120, v6
    v_mul_u32_u24 v20, 1280, v1
    v_add_u32 v9, v20, v4
    v_xor_b32 v21, 64, v9
    v_add_u32 v10, 10240, v21
    v_and_b32 v20, 1, v3
    v_lshlrev_b32 v20, 1, v20
    v_xor_b32 v20, v20, v2
    v_lshlrev_b32 v20, 4, v20
    v_mul_u32_u24 v21, 3456, v1
    v_add_u32 v11, v20, v21
    v_xor_b32 v21, 64, v11
    v_add_u32 v12, 27648, v21
    v_lshlrev_b32 v15, 4, v0
    s_cmp_eq_u32 s44, 1
    s_cselect_b64 vcc, -1, 0
    v_cndmask_b32 v13, v11, v9, vcc
    v_cndmask_b32 v14, v12, v10, vcc
    s_lshl_b32 s85, s52, 12
    s_mov_b32 s84, 0
    s_lshr_b32 s4, s52, 1
    s_and_b32 s5, s52, 1
    s_lshl_b32 s6, s42, 7
    s_lshl_b32 s4, s4, 6
    s_add_u32 s6, s6, s4
    s_lshl_b32 s7, s5, 3
    s_add_u32 s6, s6, s7
    s_mul_i32 s76, s6, 1280
    s_lshl_b32 s5, s5, 4
    s_lshl_b32 s6, s45, 5
    s_add_u32 s6, s6, s5
    s_mul_i32 s77, s6, 1280
    s_mul_i32 s7, s52, 55296
    s_lshl_b32 s6, s47, 7
    s_add_u32 s79, s6, s7
    s_lshl_b32 s6, s48, 7
    s_add_u32 s6, s6, s7
    s_add_u32 s4, s77, 40960
    s_cmp_eq_u32 s44, 1
    s_cselect_b32 s78, s4, s6
    s_movk_i32 s4, 128
    s_cselect_b32 s80, s4, 221184
    s_mov_b32 s62, 0x280000
    s_mov_b32 s63, 0x20000
    s_mov_b32 s66, 0xc8000
    s_mov_b32 s67, 0x20000
    s_mov_b32 s70, 0x21c000
    s_mov_b32 s71, 0x20000
    s_cselect_b32 s74, s66, s70
    s_mov_b32 s75, 0x20000
    s_cmp_eq_u32 s46, 27
    s_cselect_b32 s74, 0, s74
    s_waitcnt lgkmcnt(0)
    s_mov_b64 s[60:61], s[8:9]
    s_mov_b64 s[68:69], s[28:29]
    s_mov_b64 s[10:11], s[76:77]
    s_mov_b64 s[12:13], s[78:79]
    s_mov_b32 s22, s80
    s_cmp_ge_u32 s52, 2
    s_cselect_b64 s[64:65], s[16:17], s[14:15]
    s_cmp_eq_u32 s44, 1
    s_cselect_b64 s[72:73], s[64:65], s[68:69]
    s_lshl_b32 s0, s52, 11
    s_getpc_b64 s[4:5]
L_pc:
    s_lshl2_add_u32 s6, s55, s52
    s_mul_i32 s6, s6, 320
    s_min_u32 s6, s6, L_codeend-L_pc-320
    s_add_u32 s4, s4, s6
    s_addc_u32 s5, s5, 0
    s_load_dword s83, s[4:5], 0
    s_load_dword s83, s[4:5], 64
    s_load_dword s83, s[4:5], 128
    s_load_dword s83, s[4:5], 192
    s_load_dword s83, s[4:5], 256
    s_load_dword s51, s[40:41], 0x70000
    s_mul_i32 s1, s52, 10240
    s_mov_b32 s39, 81920
    s_mov_b32 s56, s40
    s_mov_b32 s57, s41
    s_mov_b32 s58, 0xfe8000
    s_mov_b32 s59, 0x20000
    s_mov_b32 s76, s32
    s_mov_b32 s77, s33
    s_mov_b32 s78, 0x21c000
    s_mov_b32 s79, 0x20000
    s_mul_i32 s4, s53, 14
    s_lshl_b32 s5, s49, 7
    s_add_u32 s6, s4, s52
    s_mul_i32 s14, s6, 81920
    s_add_u32 s14, s14, s5
    v_lshlrev_b32 v244, 1, v3
    v_xor_b32 v244, v244, v2
    v_mul_u32_u24 v245, 1280, v1
    v_lshl_add_u32 v35, v244, 4, v245
    v_lshrrev_b32 v244, 2, v0
    v_lshlrev_b32 v244, 7, v244
    v_and_b32_e64 v245, 3, v0
    v_lshl_add_u32 v244, v245, 3, v244
    v_lshl_add_u32 v33, v245, 2, s39
    v_bfe_u32 v245, v0, 3, 2
    v_lshl_add_u32 v170, v245, 5, v244
    v_xor_b32 v171, 32, v170
    v_xor_b32 v172, 64, v170
    v_xor_b32 v173, 96, v170
    v_add_u32 v166, 102400, v170
    v_add_u32 v167, 102400, v171
    v_add_u32 v168, 102400, v172
    v_add_u32 v169, 102400, v173
    v_add_u32 v174, 61440, v170
    v_add_u32 v175, 61440, v171
    v_add_u32 v176, 61440, v172
    v_add_u32 v177, 61440, v173
    v_lshlrev_b32_e64 v244, 3, v0
    v_add_u32 v16, 110592, v244
    v_add_u32 v17, 8192, v244
    v_add_u32 v18, 69632, v244
    s_mul_i32 s4, s53, 14
    s_add_u32 s4, s4, s55
    s_lshr_b32 s5, s54, 1
    s_lshl1_add_u32 s4, s4, s5
    s_lshl2_add_u32 s4, s4, s52
    s_and_b32 s6, s54, 1
    s_mul_i32 s7, s4, 10240
    s_lshl_b32 s80, s6, 7
    s_add_u32 s7, s7, s80
    s_add_u32 s7, s7, 1024
    s_lshl_b32 s4, s4, 8
    s_mul_i32 s80, s6, 229376
    s_add_u32 s4, s4, s80
    s_add_u32 s4, s4, 0x78000
    s_lshl1_add_u32 s6, s53, s6
    s_lshl4_add_u32 s6, s6, s55
    s_lshl1_add_u32 s6, s6, s5
    s_lshl_b32 s6, s6, 7
    s_add_u32 s6, s6, 0x60000
    s_add_u32 s5, s55, s53
    s_cmp_lt_u32 s5, 14
    s_cselect_b32 s7, s7, 0x80000000
    s_cselect_b32 s4, s4, 0x80000000
    s_cselect_b32 s6, s6, 0x80000000
    s_cmp_eq_u32 s52, 1
    s_cselect_b32 s6, s6, 0x80000000
    v_lshl_add_u32 v36, v0, 2, s6
    v_bfe_u32 v244, v0, 1, 3
    v_mul_u32_u24 v244, 1280, v244
    v_lshl_add_u32 v244, v3, 5, v244
    v_and_b32 v245, 1, v0
    v_lshl_add_u32 v244, v245, 4, v244
    v_add_u32_e64 v190, s7, v244
    v_mul_u32_u24 v244, 57344, v3
    v_and_b32_e64 v245, 15, v0
    v_lshl_add_u32 v244, v245, 4, v244
    v_add_u32_e64 v191, s4, v244
    s_lshr_b32 s4, s43, 2
    s_lshl_b32 s4, s4, 12
    s_add_u32 s4, s4, 0x60000
    s_lshl_b32 s6, s53, 1
    s_sub_u32 s6, 27, s6
    v_min_u32_e64 v244, s6, v0
    v_lshl_add_u32 v37, v244, 7, s4
    v_and_b32 v245, 15, v0
    v_lshrrev_b32 v246, 1, v245
    v_xor_b32 v246, v246, v3
    v_lshlrev_b32 v246, 4, v246
    v_lshl_add_u32 v244, v245, 7, v246
    v_add_u32 v19, 102400, v244
    v_xor_b32 v20, 64, v19
    v_add_u32 v21, 0, v244
    v_xor_b32 v22, 64, v21
    s_lshr_b32 s5, s1, 1
    s_add_u32 s5, s5, 40960
    v_add_u32 v244, v245, v3
    v_add_u32 v244, 0, v244
    v_and_b32_e64 v244, 15, v244
    v_lshl_add_u32 v244, v3, 4, v244
    v_lshl_add_u32 v24, v244, 4, s5
    v_add_u32 v244, v245, v3
    v_add_u32 v244, 4, v244
    v_and_b32_e64 v244, 15, v244
    v_lshl_add_u32 v244, v3, 4, v244
    v_lshl_add_u32 v25, v244, 4, s5
    v_add_u32 v244, v245, v3
    v_add_u32 v244, 8, v244
    v_and_b32_e64 v244, 15, v244
    v_lshl_add_u32 v244, v3, 4, v244
    v_lshl_add_u32 v26, v244, 4, s5
    v_add_u32 v244, v245, v3
    v_add_u32 v244, 12, v244
    v_and_b32_e64 v244, 15, v244
    v_lshl_add_u32 v244, v3, 4, v244
    v_lshl_add_u32 v27, v244, 4, s5
    s_lshl2_add_u32 s4, s53, s52
    s_xor_b32 s5, s4, 4
    s_mul_i32 s4, s4, 49152
    s_mul_i32 s5, s5, 49152
    v_add_u32 v31, s4, v15
    v_add_u32 v30, s5, v15
    s_lshl2_add_u32 s4, s52, 81920
    v_mov_b32_e64 v32, s4
    v_lshl_add_u32 v242, v0, 3, s39
    s_mul_i32 s6, s50, 393216
    s_add_u32 s15, s6, 0xe8000
    s_lshr_b32 s5, s2, 1
    s_lshl2_add_u32 s4, s5, s52
    s_mul_i32 s4, s4, 14
    v_add_u32 v244, s4, v0
    v_lshrrev_b32_e64 v245, 3, v244
    v_lshl_add_u32 v244, v245, 1, v244
    s_mul_i32 s6, s53, 1146880
    v_lshl_add_u32 v180, v244, 7, s6
    s_lshr_b32 s4, s52, 1
    s_mul_i32 s4, s4, 12
    v_add_u32 v244, s4, v0
    v_mul_u32_u24 v245, 52, v244
    v_lshrrev_b32 v245, 8, v245
    v_mul_u32_u24 v245, 5, v245
    v_add_u32_e64 v244, v244, v245
    s_mul_i32 s4, s5, 6400
    s_mul_i32 s6, s53, 640
    s_add_u32 s4, s4, s6
    v_lshl_add_u32 v181, v244, 7, s4
    s_and_b32 s4, s52, 1
    s_cselect_b64 s[16:17], s[20:21], s[18:19]
    s_cmp_eq_u32 s52, 2
    s_cselect_b32 s7, s48, s47
    s_cmp_eq_u32 s52, 1
    s_cselect_b32 s7, s45, s7
    s_min_u32 s36, s52, 2
    s_cmp_eq_u32 s52, 2
    s_cselect_b32 s4, s44, 0
    s_sub_u32 s36, s36, s4
    s_cmp_eq_u32 s36, 1
    s_cbranch_scc1 L_k1_4
    s_cmp_eq_u32 s36, 2
    s_cbranch_scc1 L_k2_5
    v_and_b32 v244, 12, v0
    v_lshlrev_b32_e64 v244, 2, v244
    v_lshl_add_u32 v244, v3, 2, v244
    v_and_b32 v245, 3, v0
    v_add_u32 v244, v244, v245
    v_lshlrev_b32_e64 v240, 5, v244
    v_lshl_add_u32 v241, v244, 2, s39
    s_lshl_b32 s4, s49, 7
    v_lshl_add_u32 v243, v0, 3, s4
    s_lshl_b32 s4, s49, 5
    s_add_u32 s4, s4, 896
    s_mov_b64 exec, 0xf0000
    v_lshl_add_u32 v243, v0, 3, s4
    s_mov_b64 exec, -1
    s_lshl_b32 s33, s42, 12
    s_add_u32 s33, s33, 0x28000
    s_branch L_ke_6
L_k1_4:
    v_and_b32 v244, 1, v3
    v_mul_u32_u24 v244, 640, v244
    v_lshrrev_b32_e64 v245, 5, v0
    v_lshl_add_u32 v244, v245, 4, v244
    v_and_b32 v245, 15, v0
    v_add_u32 v244, v244, v245
    v_lshlrev_b32 v240, 4, v244
    s_lshl_b32 s4, s52, 9
    v_add_u32 v241, s4, v242
    v_mov_b32_e64 v243, 0
    s_lshl_b32 s33, s7, 9
    s_add_u32 s33, s33, 0x38000
    s_branch L_ke_6
L_k2_5:
    v_and_b32 v244, 31, v0
    v_lshrrev_b32_e64 v245, 5, v0
    v_lshl_add_u32 v244, v244, 1, v245
    v_mov_b32 v240, v15
    s_lshl_b32 s4, s7, 7
    v_lshl_add_u32 v243, v244, 1, s4
    s_lshl_b32 s4, s52, 9
    s_add_u32 s4, s4, 81920
    v_lshl_add_u32 v241, v244, 3, s4
    s_lshl_b32 s33, s7, 12
    s_add_u32 s33, s33, 0x3d000
L_ke_6:
    s_cmp_eq_u32 s36, 1
    s_cbranch_scc1 L_k1_7
    s_cmp_eq_u32 s36, 2
    s_cbranch_scc1 L_k2_8
    s_mov_b64 exec, 0xfffff
    global_load_dwordx2 v[152:153], v243, s[24:25]
    global_load_dwordx2 v[154:155], v243, s[34:35]
    s_mov_b64 exec, -1
    s_branch L_ke_9
L_k1_7:
    s_branch L_ke_9
L_k2_8:
    global_load_ushort v164, v243, s[30:31]
L_ke_9:
    s_lshl_b32 s4, s84, 7
    s_add_u32 s23, s10, s4
    s_add_u32 s26, s11, s4
    s_add_u32 m0, s85, 0
    s_nop 0
    buffer_load_dwordx4 v5, s[60:63], s23 offen lds
    s_mul_i32 s4, s84, s22
    s_add_u32 s27, s12, s4
    s_mul_i32 s4, s84, 221184
    s_add_u32 s38, s13, s4
    s_add_u32 s84, s84, 1
    s_add_u32 m0, s85, 1024
    s_nop 0
    buffer_load_dwordx4 v6, s[60:63], s23 offen lds
    s_add_u32 m0, s85, 2048
    s_nop 0
    buffer_load_dwordx4 v7, s[60:63], s23 offen lds
    s_add_u32 m0, s85, 3072
    s_nop 0
    buffer_load_dwordx4 v8, s[60:63], s23 offen lds
    s_add_u32 m0, s0, 16384
    s_nop 0
    buffer_load_dwordx4 v9, s[64:67], s26 offen lds
    s_add_u32 m0, s0, 17408
    s_nop 0
    buffer_load_dwordx4 v10, s[64:67], s26 offen lds
    s_add_u32 m0, s0, 24576
    s_nop 0
    buffer_load_dwordx4 v13, s[72:75], s27 offen lds
    s_add_u32 m0, s0, 25600
    s_nop 0
    buffer_load_dwordx4 v14, s[72:75], s27 offen lds
    s_add_u32 m0, s0, 32768
    s_nop 0
    buffer_load_dwordx4 v11, s[68:71], s38 offen lds
    s_add_u32 m0, s0, 33792
    s_nop 0
    buffer_load_dwordx4 v12, s[68:71], s38 offen lds
    s_lshl_b32 s4, s84, 7
    s_add_u32 s23, s10, s4
    s_add_u32 s26, s11, s4
    s_add_u32 m0, s85, 40960
    s_nop 0
    buffer_load_dwordx4 v5, s[60:63], s23 offen lds
    s_mul_i32 s4, s84, s22
    s_add_u32 s27, s12, s4
    s_mul_i32 s4, s84, 221184
    s_add_u32 s38, s13, s4
    s_add_u32 s84, s84, 1
    s_add_u32 m0, s85, 41984
    s_nop 0
    buffer_load_dwordx4 v6, s[60:63], s23 offen lds
    s_add_u32 m0, s85, 43008
    s_nop 0
    buffer_load_dwordx4 v7, s[60:63], s23 offen lds
    s_add_u32 m0, s85, 44032
    s_nop 0
    buffer_load_dwordx4 v8, s[60:63], s23 offen lds
    s_add_u32 m0, s0, 57344
    s_nop 0
    buffer_load_dwordx4 v9, s[64:67], s26 offen lds
    s_add_u32 m0, s0, 58368
    s_nop 0
    buffer_load_dwordx4 v10, s[64:67], s26 offen lds
    s_add_u32 m0, s0, 65536
    s_nop 0
    buffer_load_dwordx4 v13, s[72:75], s27 offen lds
    s_add_u32 m0, s0, 66560
    s_nop 0
    buffer_load_dwordx4 v14, s[72:75], s27 offen lds
    s_add_u32 m0, s0, 73728
    s_nop 0
    buffer_load_dwordx4 v11, s[68:71], s38 offen lds
    s_add_u32 m0, s0, 74752
    s_nop 0
    buffer_load_dwordx4 v12, s[68:71], s38 offen lds
    s_waitcnt lgkmcnt(0)
    s_mul_i32 s51, s51, 0x9e3779b1
    s_add_u32 s51, s51, 0x7f4a7c15
    s_waitcnt vmcnt(10)
    s_barrier
    s_lshl_b32 s4, s84, 7
    s_add_u32 s23, s10, s4
    s_add_u32 s26, s11, s4
    s_add_u32 m0, s85, 81920
    s_nop 0
    buffer_load_dwordx4 v5, s[60:63], s23 offen lds
    s_mul_i32 s4, s84, s22
    s_add_u32 s27, s12, s4
    s_mul_i32 s4, s84, 221184
    s_add_u32 s38, s13, s4
    s_add_u32 s84, s84, 1
    s_add_u32 m0, s85, 82944
    s_nop 0
    buffer_load_dwordx4 v6, s[60:63], s23 offen lds
    s_add_u32 m0, s85, 83968
    s_nop 0
    buffer_load_dwordx4 v7, s[60:63], s23 offen lds
    s_add_u32 m0, s85, 84992
    s_nop 0
    buffer_load_dwordx4 v8, s[60:63], s23 offen lds
    s_add_u32 m0, s0, 98304
    s_nop 0
    buffer_load_dwordx4 v9, s[64:67], s26 offen lds
    s_add_u32 m0, s0, 99328
    s_nop 0
    buffer_load_dwordx4 v10, s[64:67], s26 offen lds
    s_add_u32 m0, s0, 106496
    s_nop 0
    buffer_load_dwordx4 v13, s[72:75], s27 offen lds
    s_add_u32 m0, s0, 107520
    s_nop 0
    buffer_load_dwordx4 v14, s[72:75], s27 offen lds
    s_add_u32 m0, s0, 114688
    s_nop 0
    buffer_load_dwordx4 v11, s[68:71], s38 offen lds
    s_add_u32 m0, s0, 115712
    s_nop 0
    buffer_load_dwordx4 v12, s[68:71], s38 offen lds
    s_waitcnt vmcnt(10)
    s_barrier
    s_mov_b64 exec, 0x3fff
    buffer_load_dword v182, v180, s[76:79], 0 offen
    s_mov_b64 exec, -1
    s_mov_b64 exec, 0x1fff
    global_load_dword v183, v181, s[16:17]
    s_mov_b64 exec, -1
    buffer_load_dwordx4 v[192:195], v190, s[76:79], 0 offen
    s_lshl_b32 s4, s84, 7
    s_add_u32 s23, s10, s4
    s_add_u32 s26, s11, s4
    s_add_u32 m0, s85, 122880
    s_nop 0
    buffer_load_dwordx4 v5, s[60:63], s23 offen lds
    s_mul_i32 s4, s84, s22
    s_add_u32 s27, s12, s4
    s_mul_i32 s4, s84, 221184
    s_add_u32 s38, s13, s4
    s_add_u32 s84, s84, 1
    s_add_u32 m0, s85, 123904
    s_nop 0
    buffer_load_dwordx4 v6, s[60:63], s23 offen lds
    s_add_u32 m0, s85, 124928
    s_nop 0
    buffer_load_dwordx4 v7, s[60:63], s23 offen lds
    s_add_u32 m0, s85, 125952
    s_nop 0
    buffer_load_dwordx4 v8, s[60:63], s23 offen lds
    s_add_u32 m0, s0, 139264
    s_nop 0
    buffer_load_dwordx4 v9, s[64:67], s26 offen lds
    s_add_u32 m0, s0, 140288
    s_nop 0
    buffer_load_dwordx4 v10, s[64:67], s26 offen lds
    s_add_u32 m0, s0, 147456
    s_nop 0
    buffer_load_dwordx4 v13, s[72:75], s27 offen lds
    s_add_u32 m0, s0, 148480
    s_nop 0
    buffer_load_dwordx4 v14, s[72:75], s27 offen lds
    s_add_u32 m0, s0, 155648
    s_nop 0
    buffer_load_dwordx4 v11, s[68:71], s38 offen lds
    s_add_u32 m0, s0, 156672
    s_nop 0
    buffer_load_dwordx4 v12, s[68:71], s38 offen lds
    s_waitcnt vmcnt(13)
    s_barrier
    s_cmp_eq_u32 s36, 1
    s_cbranch_scc1 L_k1_10
    s_cmp_eq_u32 s36, 2
    s_cbranch_scc1 L_k2_11
    buffer_load_dwordx2 v[148:149], v240, s[56:59], s33 offen offset:0 sc1
    buffer_load_dwordx2 v[150:151], v240, s[56:59], s33 offen offset:2048 sc1
    s_branch L_ke_12
L_k1_10:
    buffer_load_dwordx2 v[148:149], v240, s[56:59], s33 offen offset:0 sc1
    s_branch L_ke_12
L_k2_11:
    buffer_load_dwordx4 v[148:151], v240, s[56:59], s33 offen offset:0 sc1
    buffer_load_dwordx4 v[152:155], v240, s[56:59], s33 offen offset:1024 sc1
    buffer_load_dwordx4 v[156:159], v240, s[56:59], s33 offen offset:2048 sc1
    buffer_load_dwordx4 v[160:163], v240, s[56:59], s33 offen offset:3072 sc1
L_ke_12:
    s_lshl_b32 s4, s84, 7
    s_add_u32 s23, s10, s4
    s_add_u32 s26, s11, s4
    s_add_u32 m0, s85, 0
    s_nop 0
    buffer_load_dwordx4 v5, s[60:63], s23 offen lds
    s_mul_i32 s4, s84, s22
    s_add_u32 s27, s12, s4
    s_mul_i32 s4, s84, 221184
    s_add_u32 s38, s13, s4
    s_add_u32 s84, s84, 1
    s_add_u32 m0, s85, 1024
    s_nop 0
    buffer_load_dwordx4 v6, s[60:63], s23 offen lds
    s_add_u32 m0, s85, 2048
    s_nop 0
    buffer_load_dwordx4 v7, s[60:63], s23 offen lds
    s_add_u32 m0, s85, 3072
    s_nop 0
    buffer_load_dwordx4 v8, s[60:63], s23 offen lds
    s_add_u32 m0, s0, 16384
    s_nop 0
    buffer_load_dwordx4 v9, s[64:67], s26 offen lds
    s_add_u32 m0, s0, 17408
    s_nop 0
    buffer_load_dwordx4 v10, s[64:67], s26 offen lds
    s_add_u32 m0, s0, 24576
    s_nop 0
    buffer_load_dwordx4 v13, s[72:75], s27 offen lds
    s_add_u32 m0, s0, 25600
    s_nop 0
    buffer_load_dwordx4 v14, s[72:75], s27 offen lds
    s_add_u32 m0, s0, 32768
    s_nop 0
    buffer_load_dwordx4 v11, s[68:71], s38 offen lds
    s_add_u32 m0, s0, 33792
    s_nop 0
    buffer_load_dwordx4 v12, s[68:71], s38 offen lds
    s_waitcnt vmcnt(11)
    s_barrier
    buffer_store_dwordx4 v[192:195], v191, s[56:59], 0 offen sc1
    s_lshl_b32 s4, s84, 7
    s_add_u32 s23, s10, s4
    s_add_u32 s26, s11, s4
    s_add_u32 m0, s85, 40960
    s_nop 0
    buffer_load_dwordx4 v5, s[60:63], s23 offen lds
    s_mul_i32 s4, s84, s22
    s_add_u32 s27, s12, s4
    s_mul_i32 s4, s84, 221184
    s_add_u32 s38, s13, s4
    s_add_u32 s84, s84, 1
    s_add_u32 m0, s85, 41984
    s_nop 0
    buffer_load_dwordx4 v6, s[60:63], s23 offen lds
    s_add_u32 m0, s85, 43008
    s_nop 0
    buffer_load_dwordx4 v7, s[60:63], s23 offen lds
    s_add_u32 m0, s85, 44032
    s_nop 0
    buffer_load_dwordx4 v8, s[60:63], s23 offen lds
    s_add_u32 m0, s0, 57344
    s_nop 0
    buffer_load_dwordx4 v9, s[64:67], s26 offen lds
    s_add_u32 m0, s0, 58368
    s_nop 0
    buffer_load_dwordx4 v10, s[64:67], s26 offen lds
    s_add_u32 m0, s0, 65536
    s_nop 0
    buffer_load_dwordx4 v13, s[72:75], s27 offen lds
    s_add_u32 m0, s0, 66560
    s_nop 0
    buffer_load_dwordx4 v14, s[72:75], s27 offen lds
    s_add_u32 m0, s0, 73728
    s_nop 0
    buffer_load_dwordx4 v11, s[68:71], s38 offen lds
    s_add_u32 m0, s0, 74752
    s_nop 0
    buffer_load_dwordx4 v12, s[68:71], s38 offen lds
    s_waitcnt vmcnt(11)
    s_barrier
    s_lshl_b32 s4, s84, 7
    s_add_u32 s23, s10, s4
    s_add_u32 s26, s11, s4
    s_add_u32 m0, s85, 81920
    s_nop 0
    buffer_load_dwordx4 v5, s[60:63], s23 offen lds
    s_mul_i32 s4, s84, s22
    s_add_u32 s27, s12, s4
    s_mul_i32 s4, s84, 221184
    s_add_u32 s38, s13, s4
    s_add_u32 s84, s84, 1
    s_add_u32 m0, s85, 82944
    s_nop 0
    buffer_load_dwordx4 v6, s[60:63], s23 offen lds
    s_add_u32 m0, s85, 83968
    s_nop 0
    buffer_load_dwordx4 v7, s[60:63], s23 offen lds
    s_add_u32 m0, s85, 84992
    s_nop 0
    buffer_load_dwordx4 v8, s[60:63], s23 offen lds
    s_add_u32 m0, s0, 98304
    s_nop 0
    buffer_load_dwordx4 v9, s[64:67], s26 offen lds
    s_add_u32 m0, s0, 99328
    s_nop 0
    buffer_load_dwordx4 v10, s[64:67], s26 offen lds
    s_add_u32 m0, s0, 106496
    s_nop 0
    buffer_load_dwordx4 v13, s[72:75], s27 offen lds
    s_add_u32 m0, s0, 107520
    s_nop 0
    buffer_load_dwordx4 v14, s[72:75], s27 offen lds
    s_add_u32 m0, s0, 114688
    s_nop 0
    buffer_load_dwordx4 v11, s[68:71], s38 offen lds
    s_add_u32 m0, s0, 115712
    s_nop 0
    buffer_load_dwordx4 v12, s[68:71], s38 offen lds
    s_waitcnt vmcnt(10)
    s_barrier
    v_mov_b32_e64 v34, s51
    s_mov_b32 exec_hi, 0
    buffer_store_dword v34, v36, s[56:59], 0 offen sc1
    s_mov_b32 exec_hi, -1
    s_lshl_b32 s4, s84, 7
    s_add_u32 s23, s10, s4
    s_add_u32 s26, s11, s4
    s_add_u32 m0, s85, 122880
    s_nop 0
    buffer_load_dwordx4 v5, s[60:63], s23 offen lds
    s_mul_i32 s4, s84, s22
    s_add_u32 s27, s12, s4
    s_mul_i32 s4, s84, 221184
    s_add_u32 s38, s13, s4
    s_add_u32 s84, s84, 1
    s_add_u32 m0, s85, 123904
    s_nop 0
    buffer_load_dwordx4 v6, s[60:63], s23 offen lds
    s_add_u32 m0, s85, 124928
    s_nop 0
    buffer_load_dwordx4 v7, s[60:63], s23 offen lds
    s_add_u32 m0, s85, 125952
    s_nop 0
    buffer_load_dwordx4 v8, s[60:63], s23 offen lds
    s_add_u32 m0, s0, 139264
    s_nop 0
    buffer_load_dwordx4 v9, s[64:67], s26 offen lds
    s_add_u32 m0, s0, 140288
    s_nop 0
    buffer_load_dwordx4 v10, s[64:67], s26 offen lds
    s_add_u32 m0, s0, 147456
    s_nop 0
    buffer_load_dwordx4 v13, s[72:75], s27 offen lds
    s_add_u32 m0, s0, 148480
    s_nop 0
    buffer_load_dwordx4 v14, s[72:75], s27 offen lds
    s_add_u32 m0, s0, 155648
    s_nop 0
    buffer_load_dwordx4 v11, s[68:71], s38 offen lds
    s_add_u32 m0, s0, 156672
    s_nop 0
    buffer_load_dwordx4 v12, s[68:71], s38 offen lds
    s_waitcnt vmcnt(11)
    s_barrier
    s_lshl_b32 s4, s84, 7
    s_add_u32 s23, s10, s4
    s_add_u32 s26, s11, s4
    s_add_u32 m0, s85, 0
    s_nop 0
    buffer_load_dwordx4 v5, s[60:63], s23 offen lds
    s_mul_i32 s4, s84, s22
    s_add_u32 s27, s12, s4
    s_mul_i32 s4, s84, 221184
    s_add_u32 s38, s13, s4
    s_add_u32 s84, s84, 1
    s_add_u32 m0, s85, 1024
    s_nop 0
    buffer_load_dwordx4 v6, s[60:63], s23 offen lds
    s_add_u32 m0, s85, 2048
    s_nop 0
    buffer_load_dwordx4 v7, s[60:63], s23 offen lds
    s_add_u32 m0, s85, 3072
    s_nop 0
    buffer_load_dwordx4 v8, s[60:63], s23 offen lds
    s_add_u32 m0, s0, 16384
    s_nop 0
    buffer_load_dwordx4 v9, s[64:67], s26 offen lds
    s_add_u32 m0, s0, 17408
    s_nop 0
    buffer_load_dwordx4 v10, s[64:67], s26 offen lds
    s_add_u32 m0, s0, 24576
    s_nop 0
    buffer_load_dwordx4 v13, s[72:75], s27 offen lds
    s_add_u32 m0, s0, 25600
    s_nop 0
    buffer_load_dwordx4 v14, s[72:75], s27 offen lds
    s_add_u32 m0, s0, 32768
    s_nop 0
    buffer_load_dwordx4 v11, s[68:71], s38 offen lds
    s_add_u32 m0, s0, 33792
    s_nop 0
    buffer_load_dwordx4 v12, s[68:71], s38 offen lds
    s_waitcnt vmcnt(10)
    s_barrier
    s_cmp_eq_u32 s36, 1
    s_cbranch_scc0 L_fc_13
    buffer_load_dword v151, v37, s[56:59], 0 offen sc1
L_fc_13:
    s_lshl_b32 s4, s84, 7
    s_add_u32 s23, s10, s4
    s_add_u32 s26, s11, s4
    s_add_u32 m0, s85, 40960
    s_nop 0
    buffer_load_dwordx4 v5, s[60:63], s23 offen lds
    s_mul_i32 s4, s84, s22
    s_add_u32 s27, s12, s4
    s_mul_i32 s4, s84, 221184
    s_add_u32 s38, s13, s4
    s_add_u32 s84, s84, 1
    s_add_u32 m0, s85, 41984
    s_nop 0
    buffer_load_dwordx4 v6, s[60:63], s23 offen lds
    s_add_u32 m0, s85, 43008
    s_nop 0
    buffer_load_dwordx4 v7, s[60:63], s23 offen lds
    s_add_u32 m0, s85, 44032
    s_nop 0
    buffer_load_dwordx4 v8, s[60:63], s23 offen lds
    s_add_u32 m0, s0, 57344
    s_nop 0
    buffer_load_dwordx4 v9, s[64:67], s26 offen lds
    s_add_u32 m0, s0, 58368
    s_nop 0
    buffer_load_dwordx4 v10, s[64:67], s26 offen lds
    s_add_u32 m0, s0, 65536
    s_nop 0
    buffer_load_dwordx4 v13, s[72:75], s27 offen lds
    s_add_u32 m0, s0, 66560
    s_nop 0
    buffer_load_dwordx4 v14, s[72:75], s27 offen lds
    s_add_u32 m0, s0, 73728
    s_nop 0
    buffer_load_dwordx4 v11, s[68:71], s38 offen lds
    s_add_u32 m0, s0, 74752
    s_nop 0
    buffer_load_dwordx4 v12, s[68:71], s38 offen lds
    s_waitcnt vmcnt(10)
    s_barrier
    s_waitcnt vmcnt(10)
    s_cmp_eq_u32 s36, 1
    s_cbranch_scc1 L_k1_14
    s_cmp_eq_u32 s36, 2
    s_cbranch_scc1 L_k2_15
    s_mov_b32 s39, 0
    s_branch L_gc_19
L_g_17:
    buffer_load_dwordx2 v[148:149], v240, s[56:59], s33 offen offset:0 sc1
    buffer_load_dwordx2 v[150:151], v240, s[56:59], s33 offen offset:2048 sc1
    s_waitcnt vmcnt(0)
L_gc_19:
    v_cmp_ne_u32 vcc, s51, v149
    v_cmp_ne_u32 s[6:7], s51, v151
    s_or_b64 vcc, vcc, s[6:7]
    s_cbranch_vccz L_gd_18
    s_add_u32 s39, s39, 1
    s_cmp_lt_u32 s39, 0x40000
    s_cbranch_scc0 L_gd_18
    s_sleep 6
    s_branch L_g_17
L_gd_18:
    s_mov_b32 s4, 0x01000100
    v_mov_b32_e64 v149, v148
    v_and_b32 v244, 0xffff0000, v148
    v_perm_b32 v148, v148, v148, s4
    v_rcp_f32_e64 v244, v244
    ds_write_b64 v242, v[148:149] offset:0
    ds_write_b32 v241, v244 offset:2560
    v_mov_b32_e64 v151, v150
    v_and_b32 v244, 0xffff0000, v150
    v_perm_b32 v150, v150, v150, s4
    v_rcp_f32_e64 v244, v244
    ds_write_b64 v242, v[150:151] offset:512
    ds_write_b32 v241, v244 offset:2816
    v_mov_b32 v246, 0
    v_mov_b32 v247, 0
    s_mov_b64 exec, 0xffff
    ds_write_b64 v242, v[246:247] offset:3072
    s_mov_b64 exec, 0xfffff
    ds_write_b64 v242, v[152:153] offset:3200
    ds_write_b64 v242, v[154:155] offset:3872
    s_mov_b64 exec, -1
    s_branch L_ke_16
L_k1_14:
    s_mov_b32 s39, 0
    s_branch L_gc_22
L_g_20:
    buffer_load_dwordx2 v[148:149], v240, s[56:59], s33 offen offset:0 sc1
    buffer_load_dword v151, v37, s[56:59], 0 offen sc1
    s_waitcnt vmcnt(0)
L_gc_22:
    v_cmp_ne_u32 vcc, s51, v149
    v_cmp_ne_u32 s[6:7], s51, v151
    s_or_b64 vcc, vcc, s[6:7]
    s_cbranch_vccz L_gd_21
    s_add_u32 s39, s39, 1
    s_cmp_lt_u32 s39, 0x40000
    s_cbranch_scc0 L_gd_21
    s_sleep 6
    s_branch L_g_20
L_gd_21:
    v_cvt_pk_bf16_f32 v244, v148, v148
    v_lshlrev_b32 v244, 16, v244
    v_sub_f32 v244, v148, v244
    v_cvt_pk_bf16_f32 v246, v148, v244
    v_and_b32 v245, 0xffff0000, v246
    v_sub_f32_e64 v244, v244, v245
    v_cvt_pk_bf16_f32 v247, v244, v243
    ds_write_b64 v241, v[246:247] offset:512
    s_branch L_ke_16
L_k2_15:
    s_mov_b32 s39, 0
    s_branch L_gc_25
L_g_23:
    buffer_load_dwordx4 v[148:151], v240, s[56:59], s33 offen offset:0 sc1
    buffer_load_dwordx4 v[152:155], v240, s[56:59], s33 offen offset:1024 sc1
    buffer_load_dwordx4 v[156:159], v240, s[56:59], s33 offen offset:2048 sc1
    buffer_load_dwordx4 v[160:163], v240, s[56:59], s33 offen offset:3072 sc1
    s_waitcnt vmcnt(0)
L_gc_25:
    v_cmp_ne_u32 vcc, s51, v149
    v_cmp_ne_u32 s[6:7], s51, v151
    s_or_b64 vcc, vcc, s[6:7]
    v_cmp_ne_u32 s[6:7], s51, v153
    s_or_b64 vcc, vcc, s[6:7]
    v_cmp_ne_u32 s[6:7], s51, v155
    s_or_b64 vcc, vcc, s[6:7]
    v_cmp_ne_u32 s[6:7], s51, v157
    s_or_b64 vcc, vcc, s[6:7]
    v_cmp_ne_u32 s[6:7], s51, v159
    s_or_b64 vcc, vcc, s[6:7]
    v_cmp_ne_u32 s[6:7], s51, v161
    s_or_b64 vcc, vcc, s[6:7]
    v_cmp_ne_u32 s[6:7], s51, v163
    s_or_b64 vcc, vcc, s[6:7]
    s_cbranch_vccz L_gd_24
    s_add_u32 s39, s39, 1
    s_cmp_lt_u32 s39, 0x40000
    s_cbranch_scc0 L_gd_24
    s_sleep 6
    s_branch L_g_23
L_gd_24:
    v_add_f32 v148, v148, v152
    v_add_f32 v150, v150, v154
    v_add_f32 v148, v148, v156
    v_add_f32 v150, v150, v158
    v_add_f32 v148, v148, v160
    v_add_f32 v150, v150, v162
    v_lshlrev_b32 v243, 16, v164
    s_nop 0
    v_permlane32_swap_b32 v148, v150
    v_add_f32_e64 v148, v148, v150
    v_cvt_pk_bf16_f32 v244, v148, v148
    v_lshlrev_b32 v244, 16, v244
    v_sub_f32 v244, v148, v244
    v_cvt_pk_bf16_f32 v246, v148, v244
    v_and_b32 v245, 0xffff0000, v246
    v_sub_f32_e64 v244, v244, v245
    v_cvt_pk_bf16_f32 v247, v244, v243
    ds_write_b64 v241, v[246:247] offset:512
L_ke_16:
    s_lshl_b32 s4, s1, 2
    s_sub_u32 s80, s14, s4
    s_lshr_b32 s4, s52, 1
    s_lshl_b32 s4, s4, 11
    s_add_u32 s81, s4, s85
    s_add_u32 m0, s81, 102400
    s_add_u32 s5, s80, 0
    buffer_load_dwordx4 v35, s[76:79], s5 offen lds
    s_add_u32 m0, s81, 103424
    s_add_u32 s5, s80, 10240
    buffer_load_dwordx4 v35, s[76:79], s5 offen lds
    s_add_u32 m0, s81, 104448
    s_add_u32 s5, s80, 20480
    buffer_load_dwordx4 v35, s[76:79], s5 offen lds
    s_add_u32 m0, s81, 105472
    s_add_u32 s5, s80, 30720
    buffer_load_dwordx4 v35, s[76:79], s5 offen lds
    s_add_u32 m0, s1, 122880
    s_add_u32 s5, s14, 163840
    buffer_load_dwordx4 v35, s[76:79], s5 offen lds
    s_waitcnt vmcnt(5)
    s_waitcnt lgkmcnt(0)
    s_barrier
    s_add_u32 m0, s1, 123904
    s_add_u32 s5, s14, 174080
    buffer_load_dwordx4 v35, s[76:79], s5 offen lds
    s_add_u32 m0, s1, 124928
    s_add_u32 s5, s14, 184320
    buffer_load_dwordx4 v35, s[76:79], s5 offen lds
    s_add_u32 m0, s1, 125952
    s_add_u32 s5, s14, 194560
    buffer_load_dwordx4 v35, s[76:79], s5 offen lds
    s_add_u32 m0, s1, 126976
    s_add_u32 s5, s14, 204800
    buffer_load_dwordx4 v35, s[76:79], s5 offen lds
    s_add_u32 m0, s1, 128000
    s_add_u32 s5, s14, 215040
    buffer_load_dwordx4 v35, s[76:79], s5 offen lds
    s_add_u32 m0, s1, 129024
    s_add_u32 s5, s14, 225280
    buffer_load_dwordx4 v35, s[76:79], s5 offen lds
    s_add_u32 m0, s1, 130048
    s_add_u32 s5, s14, 235520
    buffer_load_dwordx4 v35, s[76:79], s5 offen lds
    s_mov_b64 s[68:69], s[56:57]
    s_mov_b32 s70, s58
    s_mul_i32 s4, s49, 57344
    s_mul_i32 s5, s53, 28672
    s_add_u32 s4, s4, s5
    s_add_u32 s4, s4, 0x78000
    s_add_u32 s82, s4, s0
    s_lshr_b32 s5, s0, 1
    s_add_u32 s5, s5, s4
    s_lshr_b32 s4, s52, 1
    s_lshl_b32 s4, s4, 13
    s_lshl_b32 s6, s52, 10
    s_add_u32 s4, s4, s6
    s_add_u32 m0, s4, 110592
    s_nop 0
    buffer_load_dwordx4 v15, s[68:71], s5 offen sc1 lds
    s_add_u32 m0, s1, 131072
    s_add_u32 s5, s82, 4096
    buffer_load_dwordx4 v15, s[68:71], s5 offen sc1 lds
    s_add_u32 m0, s1, 132096
    s_add_u32 s5, s82, 5120
    buffer_load_dwordx4 v15, s[68:71], s5 offen sc1 lds
    s_add_u32 m0, s1, 0
    s_add_u32 s5, s14, 491520
    buffer_load_dwordx4 v35, s[76:79], s5 offen lds
    s_add_u32 m0, s1, 1024
    s_add_u32 s5, s14, 501760
    buffer_load_dwordx4 v35, s[76:79], s5 offen lds
    s_add_u32 m0, s1, 2048
    s_add_u32 s5, s14, 512000
    buffer_load_dwordx4 v35, s[76:79], s5 offen lds
    s_add_u32 m0, s1, 3072
    s_add_u32 s5, s14, 522240
    buffer_load_dwordx4 v35, s[76:79], s5 offen lds
    s_add_u32 m0, s1, 4096
    s_add_u32 s5, s14, 532480
    buffer_load_dwordx4 v35, s[76:79], s5 offen lds
    s_add_u32 m0, s1, 5120
    s_add_u32 s5, s14, 542720
    buffer_load_dwordx4 v35, s[76:79], s5 offen lds
    s_add_u32 m0, s1, 6144
    s_add_u32 s5, s14, 552960
    buffer_load_dwordx4 v35, s[76:79], s5 offen lds
    s_lshl3_add_u32 s4, s50, s49
    s_mul_i32 s7, s52, 3072
    s_add_u32 s7, s7, 0xce8000
    s_mul_i32 s6, s4, 12288
    s_add_u32 s61, s6, s7
    s_xor_b32 s6, s4, 8
    s_mul_i32 s6, s6, 12288
    s_add_u32 s60, s6, s7
    s_and_b32 s62, s51, 0xffff
    s_mov_b32 s63, 0xffff0000
    v_mov_b32 v215, s51
    s_lshl2_add_u32 s4, s50, s52
    s_lshl_b32 s4, s4, 8
    s_add_u32 s4, s4, 0x58000
    s_add_u32 s6, s40, s4
    s_addc_u32 s7, s41, 0
    s_waitcnt lgkmcnt(0)
    s_barrier
    s_add_u32 m0, s1, 7168
    s_add_u32 s5, s14, 563200
    buffer_load_dwordx4 v35, s[76:79], s5 offen lds
    s_add_u32 m0, s1, 8192
    s_add_u32 s5, s82, 12288
    buffer_load_dwordx4 v15, s[68:71], s5 offen sc1 lds
    s_add_u32 m0, s1, 9216
    s_add_u32 s5, s82, 13312
    buffer_load_dwordx4 v15, s[68:71], s5 offen sc1 lds
    s_add_u32 m0, s1, 40960
    s_add_u32 s5, s14, 819200
    s_add_u32 s4, s52, s53
    s_cmp_eq_u32 s4, 4
    s_cselect_b32 s78, 0, s78
    s_cselect_b32 s70, 0, s70
    buffer_load_dwordx4 v35, s[76:79], s5 offen lds
    s_add_u32 m0, s1, 41984
    s_add_u32 s5, s14, 829440
    buffer_load_dwordx4 v35, s[76:79], s5 offen lds
    s_add_u32 m0, s1, 43008
    s_add_u32 s5, s14, 839680
    buffer_load_dwordx4 v35, s[76:79], s5 offen lds
    s_add_u32 m0, s1, 44032
    s_add_u32 s5, s14, 849920
    buffer_load_dwordx4 v35, s[76:79], s5 offen lds
    s_add_u32 m0, s1, 45056
    s_add_u32 s5, s14, 860160
    buffer_load_dwordx4 v35, s[76:79], s5 offen lds
    s_add_u32 m0, s1, 46080
    s_add_u32 s5, s14, 870400
    buffer_load_dwordx4 v35, s[76:79], s5 offen lds
    s_add_u32 m0, s1, 47104
    s_add_u32 s5, s14, 880640
    buffer_load_dwordx4 v35, s[76:79], s5 offen lds
    s_add_u32 m0, s1, 48128
    s_add_u32 s5, s14, 890880
    buffer_load_dwordx4 v35, s[76:79], s5 offen lds
    s_add_u32 m0, s1, 49152
    s_add_u32 s5, s82, 20480
    buffer_load_dwordx4 v15, s[68:71], s5 offen sc1 lds
    s_add_u32 m0, s1, 50176
    s_add_u32 s5, s82, 21504
    buffer_load_dwordx4 v15, s[68:71], s5 offen sc1 lds
    s_load_dword s64, s[6:7], 0 glc
    s_load_dword s65, s[6:7], 128 glc
    s_mov_b32 s39, 0
    s_branch L_fhc
L_fh:
    s_load_dword s64, s[6:7], 0 glc
    s_load_dword s65, s[6:7], 128 glc
L_fhc:
    s_waitcnt lgkmcnt(0)
    s_xor_b32 s64, s64, s51
    s_xor_b32 s65, s65, s51
    s_or_b32 s64, s64, s65
    s_cbranch_scc0 L_fhd
    s_add_u32 s39, s39, 1
    s_cmp_lt_u32 s39, 0x40000
    s_cbranch_scc0 L_fhd
    s_sleep 2
    s_branch L_fh
L_fhd:
    s_waitcnt vmcnt(20)
    v_mov_b32_e64 v34, 1
    ds_write_b32 v32, v34 offset:3072
    s_mov_b32 s39, 0
L_lw_26:
    ds_read_b32 v28, v33 offset:3072
    s_waitcnt lgkmcnt(0)
    v_cmp_gt_u32 vcc, 1, v28
    s_cbranch_vccz L_lw_26d
    s_add_u32 s39, s39, 1
    s_cmp_lt_u32 s39, 0x400000
    s_cbranch_scc0 L_lw_26d
    s_branch L_lw_26
L_lw_26d:
    s_add_u32 s6, s15, 0
    buffer_load_dwordx4 v[100:103], v30, s[56:59], s6 offen offset:0 sc1
    buffer_load_dwordx4 v[104:107], v31, s[56:59], s6 offen offset:0 sc1
    buffer_load_dwordx4 v[108:111], v30, s[56:59], s6 offen offset:1024 sc1
    buffer_load_dwordx4 v[112:115], v31, s[56:59], s6 offen offset:1024 sc1
    buffer_load_dwordx4 v[116:119], v30, s[56:59], s6 offen offset:2048 sc1
    buffer_load_dwordx4 v[120:123], v31, s[56:59], s6 offen offset:2048 sc1
    buffer_load_dwordx4 v[124:127], v30, s[56:59], s6 offen offset:3072 sc1
    buffer_load_dwordx4 v[128:131], v31, s[56:59], s6 offen offset:3072 sc1
    ds_read_b64_tr_b16 v[40:41], v166 offset:0
    ds_read_b64_tr_b16 v[42:43], v166 offset:2048
    ds_read_b64_tr_b16 v[44:45], v167 offset:0
    ds_read_b64_tr_b16 v[46:47], v167 offset:2048
    ds_read_b64_tr_b16 v[48:49], v168 offset:0
    ds_read_b64_tr_b16 v[50:51], v168 offset:2048
    ds_read_b64_tr_b16 v[52:53], v169 offset:0
    ds_read_b64_tr_b16 v[54:55], v169 offset:2048
    ds_read_b64_tr_b16 v[56:57], v16 offset:0
    ds_read_b64_tr_b16 v[58:59], v16 offset:512
    s_waitcnt vmcnt(7) lgkmcnt(8)
    v_mfma_f32_16x16x32_bf16 v[216:219], v[40:43], v[100:103], 0
    s_waitcnt vmcnt(6)
    ds_read_b64_tr_b16 v[60:61], v166 offset:4096
    v_mfma_f32_16x16x32_bf16 v[236:239], v[40:43], v[104:107], 0
    s_waitcnt lgkmcnt(7)
    ds_read_b64_tr_b16 v[62:63], v166 offset:6144
    v_mfma_f32_16x16x32_bf16 v[240:243], v[44:47], v[104:107], 0
    ds_read_b64_tr_b16 v[64:65], v167 offset:4096
    v_mfma_f32_16x16x32_bf16 v[220:223], v[44:47], v[100:103], 0
    s_waitcnt lgkmcnt(7)
    ds_read_b64_tr_b16 v[66:67], v167 offset:6144
    s_add_u32 s6, s15, 4096
    v_mfma_f32_16x16x32_bf16 v[224:227], v[48:51], v[100:103], 0
    ds_read_b64_tr_b16 v[68:69], v168 offset:4096
    buffer_load_dwordx4 v[132:135], v30, s[56:59], s6 offen offset:0 sc1
    v_mfma_f32_16x16x32_bf16 v[244:247], v[48:51], v[104:107], 0
    s_waitcnt lgkmcnt(7)
    ds_read_b64_tr_b16 v[70:71], v168 offset:6144
    v_mfma_f32_16x16x32_bf16 v[248:251], v[52:55], v[104:107], 0
    ds_read_b64_tr_b16 v[72:73], v169 offset:4096
    v_mfma_f32_16x16x32_bf16 v[228:231], v[52:55], v[100:103], 0
    s_waitcnt lgkmcnt(7)
    ds_read_b64_tr_b16 v[74:75], v169 offset:6144
    v_mfma_f32_16x16x32_bf16 v[232:235], v[56:59], v[100:103], 0
    ds_read_b64_tr_b16 v[76:77], v16 offset:1024
    buffer_load_dwordx4 v[136:139], v31, s[56:59], s6 offen offset:0 sc1
    v_mfma_f32_16x16x32_bf16 v[252:255], v[56:59], v[104:107], 0
    s_waitcnt vmcnt(7) lgkmcnt(7)
    ds_read_b64_tr_b16 v[78:79], v16 offset:1536
    v_mfma_f32_16x16x32_bf16 v[216:219], v[60:63], v[108:111], v[216:219]
    s_waitcnt vmcnt(6)
    ds_read_b64_tr_b16 v[80:81], v166 offset:10240
    v_mfma_f32_16x16x32_bf16 v[236:239], v[60:63], v[112:115], v[236:239]
    s_waitcnt lgkmcnt(7)
    ds_read_b64_tr_b16 v[82:83], v166 offset:12288
    v_mfma_f32_16x16x32_bf16 v[240:243], v[64:67], v[112:115], v[240:243]
    ds_read_b64_tr_b16 v[84:85], v167 offset:10240
    buffer_load_dwordx4 v[140:143], v30, s[56:59], s6 offen offset:1024 sc1
    v_mfma_f32_16x16x32_bf16 v[220:223], v[64:67], v[108:111], v[220:223]
    s_waitcnt lgkmcnt(7)
    ds_read_b64_tr_b16 v[86:87], v167 offset:12288
    v_mfma_f32_16x16x32_bf16 v[224:227], v[68:71], v[108:111], v[224:227]
    ds_read_b64_tr_b16 v[88:89], v168 offset:10240
    v_mfma_f32_16x16x32_bf16 v[244:247], v[68:71], v[112:115], v[244:247]
    s_waitcnt lgkmcnt(7)
    ds_read_b64_tr_b16 v[90:91], v168 offset:12288
    v_mfma_f32_16x16x32_bf16 v[248:251], v[72:75], v[112:115], v[248:251]
    ds_read_b64_tr_b16 v[92:93], v169 offset:10240
    buffer_load_dwordx4 v[144:147], v31, s[56:59], s6 offen offset:1024 sc1
    v_mfma_f32_16x16x32_bf16 v[228:231], v[72:75], v[108:111], v[228:231]
    s_waitcnt lgkmcnt(7)
    ds_read_b64_tr_b16 v[94:95], v169 offset:12288
    v_mfma_f32_16x16x32_bf16 v[232:235], v[76:79], v[108:111], v[232:235]
    ds_read_b64_tr_b16 v[96:97], v16 offset:10240
    v_mfma_f32_16x16x32_bf16 v[252:255], v[76:79], v[112:115], v[252:255]
    s_waitcnt vmcnt(7) lgkmcnt(7)
    ds_read_b64_tr_b16 v[98:99], v16 offset:10752
    v_mfma_f32_16x16x32_bf16 v[216:219], v[80:83], v[116:119], v[216:219]
    s_waitcnt vmcnt(6)
    ds_read_b64_tr_b16 v[40:41], v166 offset:14336
    buffer_load_dwordx4 v[148:151], v30, s[56:59], s6 offen offset:2048 sc1
    v_mfma_f32_16x16x32_bf16 v[236:239], v[80:83], v[120:123], v[236:239]
    s_waitcnt lgkmcnt(7)
    ds_read_b64_tr_b16 v[42:43], v166 offset:16384
    v_mfma_f32_16x16x32_bf16 v[240:243], v[84:87], v[120:123], v[240:243]
    ds_read_b64_tr_b16 v[44:45], v167 offset:14336
    v_mfma_f32_16x16x32_bf16 v[220:223], v[84:87], v[116:119], v[220:223]
    s_waitcnt lgkmcnt(7)
    ds_read_b64_tr_b16 v[46:47], v167 offset:16384
    v_mfma_f32_16x16x32_bf16 v[224:227], v[88:91], v[116:119], v[224:227]
    ds_read_b64_tr_b16 v[48:49], v168 offset:14336
    buffer_load_dwordx4 v[152:155], v31, s[56:59], s6 offen offset:2048 sc1
    v_mfma_f32_16x16x32_bf16 v[244:247], v[88:91], v[120:123], v[244:247]
    s_waitcnt lgkmcnt(7)
    ds_read_b64_tr_b16 v[50:51], v168 offset:16384
    v_mfma_f32_16x16x32_bf16 v[248:251], v[92:95], v[120:123], v[248:251]
    ds_read_b64_tr_b16 v[52:53], v169 offset:14336
    v_mfma_f32_16x16x32_bf16 v[228:231], v[92:95], v[116:119], v[228:231]
    s_waitcnt lgkmcnt(7)
    ds_read_b64_tr_b16 v[54:55], v169 offset:16384
    v_mfma_f32_16x16x32_bf16 v[232:235], v[96:99], v[116:119], v[232:235]
    ds_read_b64_tr_b16 v[56:57], v16 offset:11264
    buffer_load_dwordx4 v[100:103], v30, s[56:59], s6 offen offset:3072 sc1
    v_mfma_f32_16x16x32_bf16 v[252:255], v[96:99], v[120:123], v[252:255]
    s_waitcnt vmcnt(8) lgkmcnt(7)
    ds_read_b64_tr_b16 v[58:59], v16 offset:11776
    v_mfma_f32_16x16x32_bf16 v[216:219], v[40:43], v[124:127], v[216:219]
    s_waitcnt vmcnt(7)
    ds_read_b64_tr_b16 v[60:61], v166 offset:20480
    v_mfma_f32_16x16x32_bf16 v[236:239], v[40:43], v[128:131], v[236:239]
    s_waitcnt lgkmcnt(7)
    ds_read_b64_tr_b16 v[62:63], v166 offset:22528
    v_mfma_f32_16x16x32_bf16 v[240:243], v[44:47], v[128:131], v[240:243]
    ds_read_b64_tr_b16 v[64:65], v167 offset:20480
    buffer_load_dwordx4 v[104:107], v31, s[56:59], s6 offen offset:3072 sc1
    v_mfma_f32_16x16x32_bf16 v[220:223], v[44:47], v[124:127], v[220:223]
    s_waitcnt lgkmcnt(7)
    ds_read_b64_tr_b16 v[66:67], v167 offset:22528
    v_mfma_f32_16x16x32_bf16 v[224:227], v[48:51], v[124:127], v[224:227]
    ds_read_b64_tr_b16 v[68:69], v168 offset:20480
    v_mfma_f32_16x16x32_bf16 v[244:247], v[48:51], v[128:131], v[244:247]
    s_waitcnt lgkmcnt(7)
    ds_read_b64_tr_b16 v[70:71], v168 offset:22528
    s_add_u32 s6, s15, 8192
    v_mfma_f32_16x16x32_bf16 v[248:251], v[52:55], v[128:131], v[248:251]
    ds_read_b64_tr_b16 v[72:73], v169 offset:20480
    buffer_load_dwordx4 v[108:111], v30, s[56:59], s6 offen offset:0 sc1
    v_mfma_f32_16x16x32_bf16 v[228:231], v[52:55], v[124:127], v[228:231]
    s_waitcnt lgkmcnt(7)
    ds_read_b64_tr_b16 v[74:75], v169 offset:22528
    v_mfma_f32_16x16x32_bf16 v[232:235], v[56:59], v[124:127], v[232:235]
    v_mov_b32_e64 v34, 2
    ds_write_b32 v32, v34 offset:3072
    ds_read_b64_tr_b16 v[76:77], v16 offset:20480
    v_mfma_f32_16x16x32_bf16 v[252:255], v[56:59], v[128:131], v[252:255]
    s_waitcnt vmcnt(8) lgkmcnt(8)
    ds_read_b64_tr_b16 v[78:79], v16 offset:20992
    v_mfma_f32_16x16x32_bf16 v[216:219], v[60:63], v[132:135], v[216:219]
    s_waitcnt vmcnt(7)
    ds_read_b64_tr_b16 v[80:81], v166 offset:24576
    buffer_load_dwordx4 v[112:115], v31, s[56:59], s6 offen offset:0 sc1
    v_mfma_f32_16x16x32_bf16 v[236:239], v[60:63], v[136:139], v[236:239]
    s_waitcnt lgkmcnt(8)
    ds_read_b64_tr_b16 v[82:83], v166 offset:26624
    v_mfma_f32_16x16x32_bf16 v[240:243], v[64:67], v[136:139], v[240:243]
    ds_read_b64_tr_b16 v[84:85], v167 offset:24576
    v_mfma_f32_16x16x32_bf16 v[220:223], v[64:67], v[132:135], v[220:223]
    s_waitcnt lgkmcnt(8)
    ds_read_b64_tr_b16 v[86:87], v167 offset:26624
    v_mfma_f32_16x16x32_bf16 v[224:227], v[68:71], v[132:135], v[224:227]
    ds_read_b64_tr_b16 v[88:89], v168 offset:24576
    buffer_load_dwordx4 v[116:119], v30, s[56:59], s6 offen offset:1024 sc1
    v_mfma_f32_16x16x32_bf16 v[244:247], v[68:71], v[136:139], v[244:247]
    s_waitcnt lgkmcnt(8)
    ds_read_b64_tr_b16 v[90:91], v168 offset:26624
    v_mfma_f32_16x16x32_bf16 v[248:251], v[72:75], v[136:139], v[248:251]
    ds_read_b64_tr_b16 v[92:93], v169 offset:24576
    v_mfma_f32_16x16x32_bf16 v[228:231], v[72:75], v[132:135], v[228:231]
    s_waitcnt lgkmcnt(7)
    ds_read_b64_tr_b16 v[94:95], v169 offset:26624
    v_mfma_f32_16x16x32_bf16 v[232:235], v[76:79], v[132:135], v[232:235]
    ds_read_b64_tr_b16 v[96:97], v16 offset:21504
    buffer_load_dwordx4 v[120:123], v31, s[56:59], s6 offen offset:1024 sc1
    v_mfma_f32_16x16x32_bf16 v[252:255], v[76:79], v[136:139], v[252:255]
    s_waitcnt vmcnt(9) lgkmcnt(7)
    ds_read_b64_tr_b16 v[98:99], v16 offset:22016
    v_mfma_f32_16x16x32_bf16 v[216:219], v[80:83], v[140:143], v[216:219]
    s_waitcnt vmcnt(8)
    ds_read_b64_tr_b16 v[40:41], v166 offset:30720
    v_mfma_f32_16x16x32_bf16 v[236:239], v[80:83], v[144:147], v[236:239]
    s_waitcnt lgkmcnt(7)
    ds_read_b64_tr_b16 v[42:43], v166 offset:32768
    v_mfma_f32_16x16x32_bf16 v[240:243], v[84:87], v[144:147], v[240:243]
    ds_read_b64_tr_b16 v[44:45], v167 offset:30720
    buffer_load_dwordx4 v[124:127], v30, s[56:59], s6 offen offset:2048 sc1
    v_mfma_f32_16x16x32_bf16 v[220:223], v[84:87], v[140:143], v[220:223]
    s_waitcnt lgkmcnt(7)
    ds_read_b64_tr_b16 v[46:47], v167 offset:32768
    v_mfma_f32_16x16x32_bf16 v[224:227], v[88:91], v[140:143], v[224:227]
    ds_read_b64_tr_b16 v[48:49], v168 offset:30720
    v_mfma_f32_16x16x32_bf16 v[244:247], v[88:91], v[144:147], v[244:247]
    s_waitcnt lgkmcnt(7)
    ds_read_b64_tr_b16 v[50:51], v168 offset:32768
    v_mfma_f32_16x16x32_bf16 v[248:251], v[92:95], v[144:147], v[248:251]
    ds_read_b64_tr_b16 v[52:53], v169 offset:30720
    buffer_load_dwordx4 v[128:131], v31, s[56:59], s6 offen offset:2048 sc1
    v_mfma_f32_16x16x32_bf16 v[228:231], v[92:95], v[140:143], v[228:231]
    s_waitcnt lgkmcnt(7)
    ds_read_b64_tr_b16 v[54:55], v169 offset:32768
    v_mfma_f32_16x16x32_bf16 v[232:235], v[96:99], v[140:143], v[232:235]
    ds_read_b64_tr_b16 v[56:57], v16 offset:30720
    v_mfma_f32_16x16x32_bf16 v[252:255], v[96:99], v[144:147], v[252:255]
    s_waitcnt vmcnt(9) lgkmcnt(7)
    ds_read_b64_tr_b16 v[58:59], v16 offset:31232
    v_mfma_f32_16x16x32_bf16 v[216:219], v[40:43], v[148:151], v[216:219]
    s_waitcnt vmcnt(8)
    ds_read_b64_tr_b16 v[60:61], v166 offset:34816
    buffer_load_dwordx4 v[132:135], v30, s[56:59], s6 offen offset:3072 sc1
    v_mfma_f32_16x16x32_bf16 v[236:239], v[40:43], v[152:155], v[236:239]
    s_waitcnt lgkmcnt(7)
    ds_read_b64_tr_b16 v[62:63], v166 offset:36864
    v_mfma_f32_16x16x32_bf16 v[240:243], v[44:47], v[152:155], v[240:243]
    ds_read_b64_tr_b16 v[64:65], v167 offset:34816
    v_mfma_f32_16x16x32_bf16 v[220:223], v[44:47], v[148:151], v[220:223]
    s_waitcnt lgkmcnt(7)
    ds_read_b64_tr_b16 v[66:67], v167 offset:36864
    v_mfma_f32_16x16x32_bf16 v[224:227], v[48:51], v[148:151], v[224:227]
    ds_read_b64_tr_b16 v[68:69], v168 offset:34816
    buffer_load_dwordx4 v[136:139], v31, s[56:59], s6 offen offset:3072 sc1
    v_mfma_f32_16x16x32_bf16 v[244:247], v[48:51], v[152:155], v[244:247]
    s_waitcnt lgkmcnt(7)
    ds_read_b64_tr_b16 v[70:71], v168 offset:36864
    v_mfma_f32_16x16x32_bf16 v[248:251], v[52:55], v[152:155], v[248:251]
    ds_read_b64_tr_b16 v[72:73], v169 offset:34816
    v_mfma_f32_16x16x32_bf16 v[228:231], v[52:55], v[148:151], v[228:231]
    s_waitcnt lgkmcnt(7)
    ds_read_b64_tr_b16 v[74:75], v169 offset:36864
    s_add_u32 s6, s15, 12288
    v_mfma_f32_16x16x32_bf16 v[232:235], v[56:59], v[148:151], v[232:235]
    ds_read_b64_tr_b16 v[76:77], v16 offset:31744
    buffer_load_dwordx4 v[140:143], v30, s[56:59], s6 offen offset:0 sc1
    v_mfma_f32_16x16x32_bf16 v[252:255], v[56:59], v[152:155], v[252:255]
    s_waitcnt vmcnt(10) lgkmcnt(7)
    ds_read_b64_tr_b16 v[78:79], v16 offset:32256
    v_mfma_f32_16x16x32_bf16 v[216:219], v[60:63], v[100:103], v[216:219]
    s_waitcnt vmcnt(9)
    ds_read_b64_tr_b16 v[80:81], v166 offset:40960
    v_mfma_f32_16x16x32_bf16 v[236:239], v[60:63], v[104:107], v[236:239]
    s_waitcnt lgkmcnt(7)
    ds_read_b64_tr_b16 v[82:83], v166 offset:43008
    v_mfma_f32_16x16x32_bf16 v[240:243], v[64:67], v[104:107], v[240:243]
    ds_read_b64_tr_b16 v[84:85], v167 offset:40960
    buffer_load_dwordx4 v[144:147], v31, s[56:59], s6 offen offset:0 sc1
    v_mfma_f32_16x16x32_bf16 v[220:223], v[64:67], v[100:103], v[220:223]
    s_waitcnt lgkmcnt(7)
    ds_read_b64_tr_b16 v[86:87], v167 offset:43008
    v_mfma_f32_16x16x32_bf16 v[224:227], v[68:71], v[100:103], v[224:227]
    ds_read_b64_tr_b16 v[88:89], v168 offset:40960
    v_mfma_f32_16x16x32_bf16 v[244:247], v[68:71], v[104:107], v[244:247]
    s_waitcnt lgkmcnt(7)
    ds_read_b64_tr_b16 v[90:91], v168 offset:43008
    v_mfma_f32_16x16x32_bf16 v[248:251], v[72:75], v[104:107], v[248:251]
    ds_read_b64_tr_b16 v[92:93], v169 offset:40960
    buffer_load_dwordx4 v[148:151], v30, s[56:59], s6 offen offset:1024 sc1
    v_mfma_f32_16x16x32_bf16 v[228:231], v[72:75], v[100:103], v[228:231]
    s_waitcnt lgkmcnt(7)
    ds_read_b64_tr_b16 v[94:95], v169 offset:43008
    v_mfma_f32_16x16x32_bf16 v[232:235], v[76:79], v[100:103], v[232:235]
    ds_read_b64_tr_b16 v[96:97], v16 offset:40960
    v_mfma_f32_16x16x32_bf16 v[252:255], v[76:79], v[104:107], v[252:255]
    s_waitcnt vmcnt(10) lgkmcnt(7)
    ds_read_b64_tr_b16 v[98:99], v16 offset:41472
    v_mfma_f32_16x16x32_bf16 v[216:219], v[80:83], v[108:111], v[216:219]
    s_waitcnt vmcnt(9)
    ds_read_b64_tr_b16 v[40:41], v166 offset:45056
    buffer_load_dwordx4 v[152:155], v31, s[56:59], s6 offen offset:1024 sc1
    v_mfma_f32_16x16x32_bf16 v[236:239], v[80:83], v[112:115], v[236:239]
    s_waitcnt lgkmcnt(7)
    ds_read_b64_tr_b16 v[42:43], v166 offset:47104
    v_mfma_f32_16x16x32_bf16 v[240:243], v[84:87], v[112:115], v[240:243]
    ds_read_b64_tr_b16 v[44:45], v167 offset:45056
    v_mfma_f32_16x16x32_bf16 v[220:223], v[84:87], v[108:111], v[220:223]
    s_waitcnt lgkmcnt(7)
    ds_read_b64_tr_b16 v[46:47], v167 offset:47104
    v_mfma_f32_16x16x32_bf16 v[224:227], v[88:91], v[108:111], v[224:227]
    ds_read_b64_tr_b16 v[48:49], v168 offset:45056
    buffer_load_dwordx4 v[100:103], v30, s[56:59], s6 offen offset:2048 sc1
    v_mfma_f32_16x16x32_bf16 v[244:247], v[88:91], v[112:115], v[244:247]
    s_waitcnt lgkmcnt(7)
    ds_read_b64_tr_b16 v[50:51], v168 offset:47104
    v_mfma_f32_16x16x32_bf16 v[248:251], v[92:95], v[112:115], v[248:251]
    ds_read_b64_tr_b16 v[52:53], v169 offset:45056
    v_mfma_f32_16x16x32_bf16 v[228:231], v[92:95], v[108:111], v[228:231]
    s_waitcnt lgkmcnt(7)
    ds_read_b64_tr_b16 v[54:55], v169 offset:47104
    v_mfma_f32_16x16x32_bf16 v[232:235], v[96:99], v[108:111], v[232:235]
    ds_read_b64_tr_b16 v[56:57], v16 offset:41984
    buffer_load_dwordx4 v[104:107], v31, s[56:59], s6 offen offset:2048 sc1
    v_mfma_f32_16x16x32_bf16 v[252:255], v[96:99], v[112:115], v[252:255]
    s_waitcnt vmcnt(11) lgkmcnt(7)
    ds_read_b64_tr_b16 v[58:59], v16 offset:42496
    v_mfma_f32_16x16x32_bf16 v[216:219], v[40:43], v[116:119], v[216:219]
    s_waitcnt vmcnt(10)
    ds_read_b64_tr_b16 v[60:61], v166 offset:51200
    v_mfma_f32_16x16x32_bf16 v[236:239], v[40:43], v[120:123], v[236:239]
    s_waitcnt lgkmcnt(7)
    ds_read_b64_tr_b16 v[62:63], v166 offset:53248
    v_mfma_f32_16x16x32_bf16 v[240:243], v[44:47], v[120:123], v[240:243]
    v_mov_b32 v34, 3
    ds_write_b32 v32, v34 offset:3072
    ds_read_b64_tr_b16 v[64:65], v167 offset:51200
    buffer_load_dwordx4 v[108:111], v30, s[56:59], s6 offen offset:3072 sc1
    v_mfma_f32_16x16x32_bf16 v[220:223], v[44:47], v[116:119], v[220:223]
    s_waitcnt lgkmcnt(8)
    ds_read_b64_tr_b16 v[66:67], v167 offset:53248
    v_mfma_f32_16x16x32_bf16 v[224:227], v[48:51], v[116:119], v[224:227]
    ds_read_b64_tr_b16 v[68:69], v168 offset:51200
    v_mfma_f32_16x16x32_bf16 v[244:247], v[48:51], v[120:123], v[244:247]
    s_waitcnt lgkmcnt(8)
    ds_read_b64_tr_b16 v[70:71], v168 offset:53248
    v_mfma_f32_16x16x32_bf16 v[248:251], v[52:55], v[120:123], v[248:251]
    ds_read_b64_tr_b16 v[72:73], v169 offset:51200
    buffer_load_dwordx4 v[112:115], v31, s[56:59], s6 offen offset:3072 sc1
    v_mfma_f32_16x16x32_bf16 v[228:231], v[52:55], v[116:119], v[228:231]
    s_waitcnt lgkmcnt(8)
    ds_read_b64_tr_b16 v[74:75], v169 offset:53248
    v_mfma_f32_16x16x32_bf16 v[232:235], v[56:59], v[116:119], v[232:235]
    ds_read_b64_tr_b16 v[76:77], v16 offset:51200
    v_mfma_f32_16x16x32_bf16 v[252:255], v[56:59], v[120:123], v[252:255]
    s_waitcnt vmcnt(11) lgkmcnt(8)
    ds_read_b64_tr_b16 v[78:79], v16 offset:51712
    s_add_u32 s6, s15, 16384
    v_mfma_f32_16x16x32_bf16 v[216:219], v[60:63], v[124:127], v[216:219]
    s_waitcnt vmcnt(10)
    ds_read_b32 v28, v33 offset:3072
    ds_read_b64_tr_b16 v[80:81], v166 offset:55296
    buffer_load_dwordx4 v[116:119], v30, s[56:59], s6 offen offset:0 sc1
    v_mfma_f32_16x16x32_bf16 v[236:239], v[60:63], v[128:131], v[236:239]
    s_waitcnt lgkmcnt(8)
    ds_read_b64_tr_b16 v[82:83], v166 offset:57344
    v_mfma_f32_16x16x32_bf16 v[240:243], v[64:67], v[128:131], v[240:243]
    ds_read_b64_tr_b16 v[84:85], v167 offset:55296
    v_mfma_f32_16x16x32_bf16 v[220:223], v[64:67], v[124:127], v[220:223]
    s_waitcnt lgkmcnt(8)
    ds_read_b64_tr_b16 v[86:87], v167 offset:57344
    v_mfma_f32_16x16x32_bf16 v[224:227], v[68:71], v[124:127], v[224:227]
    ds_read_b64_tr_b16 v[88:89], v168 offset:55296
    buffer_load_dwordx4 v[120:123], v31, s[56:59], s6 offen offset:0 sc1
    v_mfma_f32_16x16x32_bf16 v[244:247], v[68:71], v[128:131], v[244:247]
    s_waitcnt lgkmcnt(8)
    ds_read_b64_tr_b16 v[90:91], v168 offset:57344
    v_mfma_f32_16x16x32_bf16 v[248:251], v[72:75], v[128:131], v[248:251]
    ds_read_b64_tr_b16 v[92:93], v169 offset:55296
    v_mfma_f32_16x16x32_bf16 v[228:231], v[72:75], v[124:127], v[228:231]
    s_waitcnt lgkmcnt(8)
    ds_read_b64_tr_b16 v[94:95], v169 offset:57344
    v_mfma_f32_16x16x32_bf16 v[232:235], v[76:79], v[124:127], v[232:235]
    s_waitcnt lgkmcnt(8)
    v_cmp_gt_u32 vcc, 3, v28
    s_cbranch_vccnz L_slow_27
L_back_28:
    ds_read_b64_tr_b16 v[96:97], v16 offset:52224
    v_mfma_f32_16x16x32_bf16 v[252:255], v[76:79], v[128:131], v[252:255]
    s_waitcnt vmcnt(11) lgkmcnt(7)
    ds_read_b64_tr_b16 v[98:99], v16 offset:52736
    v_mfma_f32_16x16x32_bf16 v[216:219], v[80:83], v[132:135], v[216:219]
    s_waitcnt vmcnt(10)
    ds_read_b64_tr_b16 v[40:41], v170 offset:0
    buffer_load_dwordx4 v[124:127], v30, s[56:59], s6 offen offset:1024 sc1
    v_mfma_f32_16x16x32_bf16 v[236:239], v[80:83], v[136:139], v[236:239]
    s_waitcnt lgkmcnt(7)
    ds_read_b64_tr_b16 v[42:43], v170 offset:2048
    v_mfma_f32_16x16x32_bf16 v[240:243], v[84:87], v[136:139], v[240:243]
    ds_read_b64_tr_b16 v[44:45], v171 offset:0
    v_mfma_f32_16x16x32_bf16 v[220:223], v[84:87], v[132:135], v[220:223]
    s_waitcnt lgkmcnt(7)
    ds_read_b64_tr_b16 v[46:47], v171 offset:2048
    v_mfma_f32_16x16x32_bf16 v[224:227], v[88:91], v[132:135], v[224:227]
    ds_read_b64_tr_b16 v[48:49], v172 offset:0
    buffer_load_dwordx4 v[128:131], v31, s[56:59], s6 offen offset:1024 sc1
    v_mfma_f32_16x16x32_bf16 v[244:247], v[88:91], v[136:139], v[244:247]
    s_waitcnt lgkmcnt(7)
    ds_read_b64_tr_b16 v[50:51], v172 offset:2048
    v_mfma_f32_16x16x32_bf16 v[248:251], v[92:95], v[136:139], v[248:251]
    ds_read_b64_tr_b16 v[52:53], v173 offset:0
    v_mfma_f32_16x16x32_bf16 v[228:231], v[92:95], v[132:135], v[228:231]
    s_waitcnt lgkmcnt(7)
    ds_read_b64_tr_b16 v[54:55], v173 offset:2048
    v_mfma_f32_16x16x32_bf16 v[232:235], v[96:99], v[132:135], v[232:235]
    v_mov_b32_e64 v34, 4
    ds_write_b32 v32, v34 offset:3072
    ds_read_b64_tr_b16 v[56:57], v17 offset:0
    v_mfma_f32_16x16x32_bf16 v[252:255], v[96:99], v[136:139], v[252:255]
    s_waitcnt vmcnt(11) lgkmcnt(8)
    ds_read_b64_tr_b16 v[58:59], v17 offset:512
    v_mfma_f32_16x16x32_bf16 v[216:219], v[40:43], v[140:143], v[216:219]
    s_waitcnt vmcnt(10)
    ds_read_b64_tr_b16 v[60:61], v170 offset:4096
    buffer_load_dwordx4 v[132:135], v30, s[56:59], s6 offen offset:2048 sc1
    v_mfma_f32_16x16x32_bf16 v[236:239], v[40:43], v[144:147], v[236:239]
    s_waitcnt lgkmcnt(8)
    ds_read_b64_tr_b16 v[62:63], v170 offset:6144
    v_mfma_f32_16x16x32_bf16 v[240:243], v[44:47], v[144:147], v[240:243]
    ds_read_b64_tr_b16 v[64:65], v171 offset:4096
    v_mfma_f32_16x16x32_bf16 v[220:223], v[44:47], v[140:143], v[220:223]
    s_waitcnt lgkmcnt(8)
    ds_read_b64_tr_b16 v[66:67], v171 offset:6144
    v_mfma_f32_16x16x32_bf16 v[224:227], v[48:51], v[140:143], v[224:227]
    ds_read_b64_tr_b16 v[68:69], v172 offset:4096
    buffer_load_dwordx4 v[136:139], v31, s[56:59], s6 offen offset:2048 sc1
    v_mfma_f32_16x16x32_bf16 v[244:247], v[48:51], v[144:147], v[244:247]
    s_waitcnt lgkmcnt(8)
    ds_read_b64_tr_b16 v[70:71], v172 offset:6144
    v_mfma_f32_16x16x32_bf16 v[248:251], v[52:55], v[144:147], v[248:251]
    ds_read_b64_tr_b16 v[72:73], v173 offset:4096
    v_mfma_f32_16x16x32_bf16 v[228:231], v[52:55], v[140:143], v[228:231]
    s_waitcnt lgkmcnt(7)
    ds_read_b64_tr_b16 v[74:75], v173 offset:6144
    v_mfma_f32_16x16x32_bf16 v[232:235], v[56:59], v[140:143], v[232:235]
    ds_read_b64_tr_b16 v[76:77], v17 offset:1024
    v_mfma_f32_16x16x32_bf16 v[252:255], v[56:59], v[144:147], v[252:255]
    s_waitcnt vmcnt(11) lgkmcnt(7)
    ds_read_b64_tr_b16 v[78:79], v17 offset:1536
    v_mfma_f32_16x16x32_bf16 v[216:219], v[60:63], v[148:151], v[216:219]
    s_waitcnt vmcnt(10)
    ds_read_b64_tr_b16 v[80:81], v170 offset:10240
    buffer_load_dwordx4 v[140:143], v30, s[56:59], s6 offen offset:3072 sc1
    v_mfma_f32_16x16x32_bf16 v[236:239], v[60:63], v[152:155], v[236:239]
    s_waitcnt lgkmcnt(7)
    ds_read_b64_tr_b16 v[82:83], v170 offset:12288
    v_mfma_f32_16x16x32_bf16 v[240:243], v[64:67], v[152:155], v[240:243]
    ds_read_b64_tr_b16 v[84:85], v171 offset:10240
    v_mfma_f32_16x16x32_bf16 v[220:223], v[64:67], v[148:151], v[220:223]
    s_waitcnt lgkmcnt(7)
    ds_read_b64_tr_b16 v[86:87], v171 offset:12288
    v_mfma_f32_16x16x32_bf16 v[224:227], v[68:71], v[148:151], v[224:227]
    ds_read_b64_tr_b16 v[88:89], v172 offset:10240
    buffer_load_dwordx4 v[144:147], v31, s[56:59], s6 offen offset:3072 sc1
    v_mfma_f32_16x16x32_bf16 v[244:247], v[68:71], v[152:155], v[244:247]
    s_waitcnt lgkmcnt(7)
    ds_read_b64_tr_b16 v[90:91], v172 offset:12288
    v_mfma_f32_16x16x32_bf16 v[248:251], v[72:75], v[152:155], v[248:251]
    ds_read_b64_tr_b16 v[92:93], v173 offset:10240
    v_mfma_f32_16x16x32_bf16 v[228:231], v[72:75], v[148:151], v[228:231]
    s_waitcnt lgkmcnt(7)
    ds_read_b64_tr_b16 v[94:95], v173 offset:12288
    v_mfma_f32_16x16x32_bf16 v[232:235], v[76:79], v[148:151], v[232:235]
    ds_read_b64_tr_b16 v[96:97], v17 offset:10240
    v_mfma_f32_16x16x32_bf16 v[252:255], v[76:79], v[152:155], v[252:255]
    s_waitcnt vmcnt(11) lgkmcnt(7)
    ds_read_b64_tr_b16 v[98:99], v17 offset:10752
    s_add_u32 s6, s15, 20480
    v_mfma_f32_16x16x32_bf16 v[216:219], v[80:83], v[100:103], v[216:219]
    s_waitcnt vmcnt(10)
    ds_read_b64_tr_b16 v[40:41], v170 offset:14336
    buffer_load_dwordx4 v[148:151], v30, s[56:59], s6 offen offset:0 sc1
    v_mfma_f32_16x16x32_bf16 v[236:239], v[80:83], v[104:107], v[236:239]
    s_waitcnt lgkmcnt(7)
    ds_read_b64_tr_b16 v[42:43], v170 offset:16384
    v_mfma_f32_16x16x32_bf16 v[240:243], v[84:87], v[104:107], v[240:243]
    ds_read_b64_tr_b16 v[44:45], v171 offset:14336
    v_mfma_f32_16x16x32_bf16 v[220:223], v[84:87], v[100:103], v[220:223]
    s_waitcnt lgkmcnt(7)
    ds_read_b64_tr_b16 v[46:47], v171 offset:16384
    v_mfma_f32_16x16x32_bf16 v[224:227], v[88:91], v[100:103], v[224:227]
    ds_read_b64_tr_b16 v[48:49], v172 offset:14336
    buffer_load_dwordx4 v[152:155], v31, s[56:59], s6 offen offset:0 sc1
    v_mfma_f32_16x16x32_bf16 v[244:247], v[88:91], v[104:107], v[244:247]
    s_waitcnt lgkmcnt(7)
    ds_read_b64_tr_b16 v[50:51], v172 offset:16384
    v_mfma_f32_16x16x32_bf16 v[248:251], v[92:95], v[104:107], v[248:251]
    ds_read_b64_tr_b16 v[52:53], v173 offset:14336
    v_mfma_f32_16x16x32_bf16 v[228:231], v[92:95], v[100:103], v[228:231]
    s_waitcnt lgkmcnt(7)
    ds_read_b64_tr_b16 v[54:55], v173 offset:16384
    v_mfma_f32_16x16x32_bf16 v[232:235], v[96:99], v[100:103], v[232:235]
    ds_read_b64_tr_b16 v[56:57], v17 offset:11264
    v_mfma_f32_16x16x32_bf16 v[252:255], v[96:99], v[104:107], v[252:255]
    s_waitcnt vmcnt(11) lgkmcnt(7)
    ds_read_b64_tr_b16 v[58:59], v17 offset:11776
    v_mfma_f32_16x16x32_bf16 v[216:219], v[40:43], v[108:111], v[216:219]
    s_waitcnt vmcnt(10)
    ds_read_b64_tr_b16 v[60:61], v170 offset:20480
    buffer_load_dwordx4 v[100:103], v30, s[56:59], s6 offen offset:1024 sc1
    v_mfma_f32_16x16x32_bf16 v[236:239], v[40:43], v[112:115], v[236:239]
    s_waitcnt lgkmcnt(7)
    ds_read_b64_tr_b16 v[62:63], v170 offset:22528
    v_mfma_f32_16x16x32_bf16 v[240:243], v[44:47], v[112:115], v[240:243]
    ds_read_b64_tr_b16 v[64:65], v171 offset:20480
    v_mfma_f32_16x16x32_bf16 v[220:223], v[44:47], v[108:111], v[220:223]
    s_waitcnt lgkmcnt(7)
    ds_read_b64_tr_b16 v[66:67], v171 offset:22528
    v_mfma_f32_16x16x32_bf16 v[224:227], v[48:51], v[108:111], v[224:227]
    ds_read_b64_tr_b16 v[68:69], v172 offset:20480
    buffer_load_dwordx4 v[104:107], v31, s[56:59], s6 offen offset:1024 sc1
    v_mfma_f32_16x16x32_bf16 v[244:247], v[48:51], v[112:115], v[244:247]
    s_waitcnt lgkmcnt(7)
    ds_read_b64_tr_b16 v[70:71], v172 offset:22528
    v_mfma_f32_16x16x32_bf16 v[248:251], v[52:55], v[112:115], v[248:251]
    ds_read_b64_tr_b16 v[72:73], v173 offset:20480
    v_mfma_f32_16x16x32_bf16 v[228:231], v[52:55], v[108:111], v[228:231]
    s_waitcnt lgkmcnt(7)
    ds_read_b64_tr_b16 v[74:75], v173 offset:22528
    v_mfma_f32_16x16x32_bf16 v[232:235], v[56:59], v[108:111], v[232:235]
    ds_read_b64_tr_b16 v[76:77], v17 offset:20480
    v_mfma_f32_16x16x32_bf16 v[252:255], v[56:59], v[112:115], v[252:255]
    s_waitcnt vmcnt(11) lgkmcnt(7)
    ds_read_b64_tr_b16 v[78:79], v17 offset:20992
    v_mfma_f32_16x16x32_bf16 v[216:219], v[60:63], v[116:119], v[216:219]
    s_waitcnt vmcnt(10)
    ds_read_b64_tr_b16 v[80:81], v170 offset:24576
    buffer_load_dwordx4 v[108:111], v30, s[56:59], s6 offen offset:2048 sc1
    v_mfma_f32_16x16x32_bf16 v[236:239], v[60:63], v[120:123], v[236:239]
    s_waitcnt lgkmcnt(7)
    ds_read_b64_tr_b16 v[82:83], v170 offset:26624
    v_mfma_f32_16x16x32_bf16 v[240:243], v[64:67], v[120:123], v[240:243]
    ds_read_b64_tr_b16 v[84:85], v171 offset:24576
    v_mfma_f32_16x16x32_bf16 v[220:223], v[64:67], v[116:119], v[220:223]
    s_waitcnt lgkmcnt(7)
    ds_read_b64_tr_b16 v[86:87], v171 offset:26624
    v_mfma_f32_16x16x32_bf16 v[224:227], v[68:71], v[116:119], v[224:227]
    ds_read_b64_tr_b16 v[88:89], v172 offset:24576
    buffer_load_dwordx4 v[112:115], v31, s[56:59], s6 offen offset:2048 sc1
    v_mfma_f32_16x16x32_bf16 v[244:247], v[68:71], v[120:123], v[244:247]
    s_waitcnt lgkmcnt(7)
    ds_read_b64_tr_b16 v[90:91], v172 offset:26624
    v_mfma_f32_16x16x32_bf16 v[248:251], v[72:75], v[120:123], v[248:251]
    ds_read_b64_tr_b16 v[92:93], v173 offset:24576
    v_mfma_f32_16x16x32_bf16 v[228:231], v[72:75], v[116:119], v[228:231]
    s_waitcnt lgkmcnt(7)
    ds_read_b64_tr_b16 v[94:95], v173 offset:26624
    v_mfma_f32_16x16x32_bf16 v[232:235], v[76:79], v[116:119], v[232:235]
    ds_read_b64_tr_b16 v[96:97], v17 offset:21504
    v_mfma_f32_16x16x32_bf16 v[252:255], v[76:79], v[120:123], v[252:255]
    s_waitcnt vmcnt(11) lgkmcnt(7)
    ds_read_b64_tr_b16 v[98:99], v17 offset:22016
    v_mfma_f32_16x16x32_bf16 v[216:219], v[80:83], v[124:127], v[216:219]
    s_waitcnt vmcnt(10)
    ds_read_b64_tr_b16 v[40:41], v170 offset:30720
    buffer_load_dwordx4 v[116:119], v30, s[56:59], s6 offen offset:3072 sc1
    v_mfma_f32_16x16x32_bf16 v[236:239], v[80:83], v[128:131], v[236:239]
    s_waitcnt lgkmcnt(7)
    ds_read_b64_tr_b16 v[42:43], v170 offset:32768
    v_mfma_f32_16x16x32_bf16 v[240:243], v[84:87], v[128:131], v[240:243]
    ds_read_b64_tr_b16 v[44:45], v171 offset:30720
    v_mfma_f32_16x16x32_bf16 v[220:223], v[84:87], v[124:127], v[220:223]
    s_waitcnt lgkmcnt(7)
    ds_read_b64_tr_b16 v[46:47], v171 offset:32768
    v_mfma_f32_16x16x32_bf16 v[224:227], v[88:91], v[124:127], v[224:227]
    ds_read_b64_tr_b16 v[48:49], v172 offset:30720
    buffer_load_dwordx4 v[120:123], v31, s[56:59], s6 offen offset:3072 sc1
    v_mfma_f32_16x16x32_bf16 v[244:247], v[88:91], v[128:131], v[244:247]
    s_waitcnt lgkmcnt(7)
    ds_read_b64_tr_b16 v[50:51], v172 offset:32768
    v_mfma_f32_16x16x32_bf16 v[248:251], v[92:95], v[128:131], v[248:251]
    ds_read_b64_tr_b16 v[52:53], v173 offset:30720
    v_mfma_f32_16x16x32_bf16 v[228:231], v[92:95], v[124:127], v[228:231]
    s_waitcnt lgkmcnt(7)
    ds_read_b64_tr_b16 v[54:55], v173 offset:32768
    v_mfma_f32_16x16x32_bf16 v[232:235], v[96:99], v[124:127], v[232:235]
    ds_read_b64_tr_b16 v[56:57], v17 offset:30720
    v_mfma_f32_16x16x32_bf16 v[252:255], v[96:99], v[128:131], v[252:255]
    s_waitcnt vmcnt(11) lgkmcnt(7)
    ds_read_b64_tr_b16 v[58:59], v17 offset:31232
    s_add_u32 s6, s15, 24576
    v_mfma_f32_16x16x32_bf16 v[216:219], v[40:43], v[132:135], v[216:219]
    s_waitcnt vmcnt(10)
    ds_read_b64_tr_b16 v[60:61], v170 offset:34816
    buffer_load_dwordx4 v[124:127], v30, s[56:59], s6 offen offset:0 sc1
    v_mfma_f32_16x16x32_bf16 v[236:239], v[40:43], v[136:139], v[236:239]
    s_waitcnt lgkmcnt(7)
    ds_read_b64_tr_b16 v[62:63], v170 offset:36864
    v_mfma_f32_16x16x32_bf16 v[240:243], v[44:47], v[136:139], v[240:243]
    ds_read_b64_tr_b16 v[64:65], v171 offset:34816
    v_mfma_f32_16x16x32_bf16 v[220:223], v[44:47], v[132:135], v[220:223]
    s_waitcnt lgkmcnt(7)
    ds_read_b64_tr_b16 v[66:67], v171 offset:36864
    v_mfma_f32_16x16x32_bf16 v[224:227], v[48:51], v[132:135], v[224:227]
    ds_read_b64_tr_b16 v[68:69], v172 offset:34816
    buffer_load_dwordx4 v[128:131], v31, s[56:59], s6 offen offset:0 sc1
    v_mfma_f32_16x16x32_bf16 v[244:247], v[48:51], v[136:139], v[244:247]
    s_waitcnt lgkmcnt(7)
    ds_read_b64_tr_b16 v[70:71], v172 offset:36864
    v_mfma_f32_16x16x32_bf16 v[248:251], v[52:55], v[136:139], v[248:251]
    ds_read_b64_tr_b16 v[72:73], v173 offset:34816
    v_mfma_f32_16x16x32_bf16 v[228:231], v[52:55], v[132:135], v[228:231]
    s_waitcnt lgkmcnt(7)
    ds_read_b64_tr_b16 v[74:75], v173 offset:36864
    v_mfma_f32_16x16x32_bf16 v[232:235], v[56:59], v[132:135], v[232:235]
    ds_read_b64_tr_b16 v[76:77], v17 offset:31744
    v_mfma_f32_16x16x32_bf16 v[252:255], v[56:59], v[136:139], v[252:255]
    s_waitcnt vmcnt(11) lgkmcnt(7)
    ds_read_b64_tr_b16 v[78:79], v17 offset:32256
    v_mfma_f32_16x16x32_bf16 v[216:219], v[60:63], v[140:143], v[216:219]
    s_waitcnt vmcnt(10)
    ds_read_b64_tr_b16 v[80:81], v170 offset:40960
    buffer_load_dwordx4 v[132:135], v30, s[56:59], s6 offen offset:1024 sc1
    v_mfma_f32_16x16x32_bf16 v[236:239], v[60:63], v[144:147], v[236:239]
    s_waitcnt lgkmcnt(7)
    ds_read_b64_tr_b16 v[82:83], v170 offset:43008
    v_mfma_f32_16x16x32_bf16 v[240:243], v[64:67], v[144:147], v[240:243]
    ds_read_b64_tr_b16 v[84:85], v171 offset:40960
    v_mfma_f32_16x16x32_bf16 v[220:223], v[64:67], v[140:143], v[220:223]
    s_waitcnt lgkmcnt(7)
    ds_read_b64_tr_b16 v[86:87], v171 offset:43008
    v_mfma_f32_16x16x32_bf16 v[224:227], v[68:71], v[140:143], v[224:227]
    ds_read_b64_tr_b16 v[88:89], v172 offset:40960
    buffer_load_dwordx4 v[136:139], v31, s[56:59], s6 offen offset:1024 sc1
    v_mfma_f32_16x16x32_bf16 v[244:247], v[68:71], v[144:147], v[244:247]
    s_waitcnt lgkmcnt(7)
    ds_read_b64_tr_b16 v[90:91], v172 offset:43008
    v_mfma_f32_16x16x32_bf16 v[248:251], v[72:75], v[144:147], v[248:251]
    ds_read_b64_tr_b16 v[92:93], v173 offset:40960
    v_mfma_f32_16x16x32_bf16 v[228:231], v[72:75], v[140:143], v[228:231]
    s_waitcnt lgkmcnt(7)
    ds_read_b64_tr_b16 v[94:95], v173 offset:43008
    v_mfma_f32_16x16x32_bf16 v[232:235], v[76:79], v[140:143], v[232:235]
    v_mov_b32_e64 v34, 5
    ds_write_b32 v32, v34 offset:3072
    ds_read_b64_tr_b16 v[96:97], v17 offset:40960
    v_mfma_f32_16x16x32_bf16 v[252:255], v[76:79], v[144:147], v[252:255]
    s_waitcnt vmcnt(11) lgkmcnt(8)
    ds_read_b64_tr_b16 v[98:99], v17 offset:41472
    v_mfma_f32_16x16x32_bf16 v[216:219], v[80:83], v[148:151], v[216:219]
    s_waitcnt vmcnt(10)
    ds_read_b64_tr_b16 v[40:41], v170 offset:45056
    buffer_load_dwordx4 v[140:143], v30, s[56:59], s6 offen offset:2048 sc1
    v_mfma_f32_16x16x32_bf16 v[236:239], v[80:83], v[152:155], v[236:239]
    s_waitcnt lgkmcnt(8)
    ds_read_b64_tr_b16 v[42:43], v170 offset:47104
    v_mfma_f32_16x16x32_bf16 v[240:243], v[84:87], v[152:155], v[240:243]
    ds_read_b64_tr_b16 v[44:45], v171 offset:45056
    v_mfma_f32_16x16x32_bf16 v[220:223], v[84:87], v[148:151], v[220:223]
    s_waitcnt lgkmcnt(8)
    ds_read_b64_tr_b16 v[46:47], v171 offset:47104
    v_mfma_f32_16x16x32_bf16 v[224:227], v[88:91], v[148:151], v[224:227]
    ds_read_b64_tr_b16 v[48:49], v172 offset:45056
    buffer_load_dwordx4 v[144:147], v31, s[56:59], s6 offen offset:2048 sc1
    v_mfma_f32_16x16x32_bf16 v[244:247], v[88:91], v[152:155], v[244:247]
    s_waitcnt lgkmcnt(8)
    ds_read_b64_tr_b16 v[50:51], v172 offset:47104
    v_mfma_f32_16x16x32_bf16 v[248:251], v[92:95], v[152:155], v[248:251]
    ds_read_b32 v29, v33 offset:3120
    ds_read_b64_tr_b16 v[52:53], v173 offset:45056
    v_mfma_f32_16x16x32_bf16 v[228:231], v[92:95], v[148:151], v[228:231]
    s_waitcnt lgkmcnt(8)
    ds_read_b64_tr_b16 v[54:55], v173 offset:47104
    v_mfma_f32_16x16x32_bf16 v[232:235], v[96:99], v[148:151], v[232:235]
    ds_read_b64_tr_b16 v[56:57], v17 offset:41984
    v_mfma_f32_16x16x32_bf16 v[252:255], v[96:99], v[152:155], v[252:255]
    s_waitcnt vmcnt(11) lgkmcnt(8)
    ds_read_b64_tr_b16 v[58:59], v17 offset:42496
    v_mfma_f32_16x16x32_bf16 v[216:219], v[40:43], v[100:103], v[216:219]
    s_waitcnt vmcnt(10)
    ds_read_b64_tr_b16 v[60:61], v170 offset:51200
    buffer_load_dwordx4 v[148:151], v30, s[56:59], s6 offen offset:3072 sc1
    v_mfma_f32_16x16x32_bf16 v[236:239], v[40:43], v[104:107], v[236:239]
    s_waitcnt lgkmcnt(8)
    ds_read_b64_tr_b16 v[62:63], v170 offset:53248
    v_mfma_f32_16x16x32_bf16 v[240:243], v[44:47], v[104:107], v[240:243]
    ds_read_b64_tr_b16 v[64:65], v171 offset:51200
    v_mfma_f32_16x16x32_bf16 v[220:223], v[44:47], v[100:103], v[220:223]
    s_waitcnt lgkmcnt(8)
    ds_read_b64_tr_b16 v[66:67], v171 offset:53248
    v_mfma_f32_16x16x32_bf16 v[224:227], v[48:51], v[100:103], v[224:227]
    s_waitcnt lgkmcnt(8)
    v_cmp_gt_u32 vcc, 1, v29
    s_cbranch_vccnz L_slow_29
L_back_30:
    ds_read_b64_tr_b16 v[68:69], v172 offset:51200
    buffer_load_dwordx4 v[152:155], v31, s[56:59], s6 offen offset:3072 sc1
    v_mfma_f32_16x16x32_bf16 v[244:247], v[48:51], v[104:107], v[244:247]
    s_waitcnt lgkmcnt(7)
    ds_read_b64_tr_b16 v[70:71], v172 offset:53248
    v_mfma_f32_16x16x32_bf16 v[248:251], v[52:55], v[104:107], v[248:251]
    ds_read_b64_tr_b16 v[72:73], v173 offset:51200
    v_mfma_f32_16x16x32_bf16 v[228:231], v[52:55], v[100:103], v[228:231]
    s_waitcnt lgkmcnt(7)
    ds_read_b64_tr_b16 v[74:75], v173 offset:53248
    v_mfma_f32_16x16x32_bf16 v[232:235], v[56:59], v[100:103], v[232:235]
    ds_read_b64_tr_b16 v[76:77], v17 offset:51200
    v_mfma_f32_16x16x32_bf16 v[252:255], v[56:59], v[104:107], v[252:255]
    s_waitcnt vmcnt(11) lgkmcnt(7)
    ds_read_b64_tr_b16 v[78:79], v17 offset:51712
    s_add_u32 s6, s15, 28672
    v_mfma_f32_16x16x32_bf16 v[216:219], v[60:63], v[108:111], v[216:219]
    s_waitcnt vmcnt(10)
    ds_read_b64_tr_b16 v[80:81], v170 offset:55296
    buffer_load_dwordx4 v[100:103], v30, s[56:59], s6 offen offset:0 sc1
    v_mfma_f32_16x16x32_bf16 v[236:239], v[60:63], v[112:115], v[236:239]
    s_waitcnt lgkmcnt(7)
    ds_read_b64_tr_b16 v[82:83], v170 offset:57344
    v_mfma_f32_16x16x32_bf16 v[240:243], v[64:67], v[112:115], v[240:243]
    ds_read_b64_tr_b16 v[84:85], v171 offset:55296
    v_mfma_f32_16x16x32_bf16 v[220:223], v[64:67], v[108:111], v[220:223]
    s_waitcnt lgkmcnt(7)
    ds_read_b64_tr_b16 v[86:87], v171 offset:57344
    v_mfma_f32_16x16x32_bf16 v[224:227], v[68:71], v[108:111], v[224:227]
    ds_read_b64_tr_b16 v[88:89], v172 offset:55296
    buffer_load_dwordx4 v[104:107], v30, s[56:59], s6 offen offset:1024 sc1
    v_mfma_f32_16x16x32_bf16 v[244:247], v[68:71], v[112:115], v[244:247]
    s_waitcnt lgkmcnt(7)
    ds_read_b64_tr_b16 v[90:91], v172 offset:57344
    v_mfma_f32_16x16x32_bf16 v[248:251], v[72:75], v[112:115], v[248:251]
    ds_read_b64_tr_b16 v[92:93], v173 offset:55296
    v_mfma_f32_16x16x32_bf16 v[228:231], v[72:75], v[108:111], v[228:231]
    s_waitcnt lgkmcnt(7)
    ds_read_b64_tr_b16 v[94:95], v173 offset:57344
    v_mfma_f32_16x16x32_bf16 v[232:235], v[76:79], v[108:111], v[232:235]
    ds_read_b64_tr_b16 v[96:97], v17 offset:52224
    v_mfma_f32_16x16x32_bf16 v[252:255], v[76:79], v[112:115], v[252:255]
    s_waitcnt vmcnt(11) lgkmcnt(7)
    ds_read_b64_tr_b16 v[98:99], v17 offset:52736
    v_mfma_f32_16x16x32_bf16 v[216:219], v[80:83], v[116:119], v[216:219]
    s_waitcnt vmcnt(10)
    ds_read_b64_tr_b16 v[40:41], v174 offset:0
    buffer_load_dwordx4 v[108:111], v30, s[56:59], s6 offen offset:2048 sc1
    v_mfma_f32_16x16x32_bf16 v[236:239], v[80:83], v[120:123], v[236:239]
    s_waitcnt lgkmcnt(7)
    ds_read_b64_tr_b16 v[42:43], v174 offset:2048
    v_mfma_f32_16x16x32_bf16 v[240:243], v[84:87], v[120:123], v[240:243]
    ds_read_b64_tr_b16 v[44:45], v175 offset:0
    v_mfma_f32_16x16x32_bf16 v[220:223], v[84:87], v[116:119], v[220:223]
    s_waitcnt lgkmcnt(7)
    ds_read_b64_tr_b16 v[46:47], v175 offset:2048
    v_mfma_f32_16x16x32_bf16 v[224:227], v[88:91], v[116:119], v[224:227]
    ds_read_b64_tr_b16 v[48:49], v176 offset:0
    buffer_load_dwordx4 v[112:115], v30, s[56:59], s6 offen offset:3072 sc1
    v_mfma_f32_16x16x32_bf16 v[244:247], v[88:91], v[120:123], v[244:247]
    s_waitcnt lgkmcnt(7)
    ds_read_b64_tr_b16 v[50:51], v176 offset:2048
    v_mfma_f32_16x16x32_bf16 v[248:251], v[92:95], v[120:123], v[248:251]
    ds_read_b64_tr_b16 v[52:53], v177 offset:0
    v_mfma_f32_16x16x32_bf16 v[228:231], v[92:95], v[116:119], v[228:231]
    s_waitcnt lgkmcnt(7)
    ds_read_b64_tr_b16 v[54:55], v177 offset:2048
    v_mfma_f32_16x16x32_bf16 v[232:235], v[96:99], v[116:119], v[232:235]
    ds_read_b64_tr_b16 v[56:57], v18 offset:0
    v_mfma_f32_16x16x32_bf16 v[252:255], v[96:99], v[120:123], v[252:255]
    s_waitcnt vmcnt(11) lgkmcnt(7)
    ds_read_b64_tr_b16 v[58:59], v18 offset:512
    s_add_u32 s6, s15, 32768
    v_mfma_f32_16x16x32_bf16 v[216:219], v[40:43], v[124:127], v[216:219]
    s_waitcnt vmcnt(10)
    ds_read_b64_tr_b16 v[60:61], v174 offset:4096
    buffer_load_dwordx4 v[116:119], v30, s[56:59], s6 offen offset:0 sc1
    v_mfma_f32_16x16x32_bf16 v[236:239], v[40:43], v[128:131], v[236:239]
    s_waitcnt lgkmcnt(7)
    ds_read_b64_tr_b16 v[62:63], v174 offset:6144
    v_mfma_f32_16x16x32_bf16 v[240:243], v[44:47], v[128:131], v[240:243]
    ds_read_b64_tr_b16 v[64:65], v175 offset:4096
    v_mfma_f32_16x16x32_bf16 v[220:223], v[44:47], v[124:127], v[220:223]
    s_waitcnt lgkmcnt(7)
    ds_read_b64_tr_b16 v[66:67], v175 offset:6144
    v_mfma_f32_16x16x32_bf16 v[224:227], v[48:51], v[124:127], v[224:227]
    ds_read_b64_tr_b16 v[68:69], v176 offset:4096
    buffer_load_dwordx4 v[120:123], v30, s[56:59], s6 offen offset:1024 sc1
    v_mfma_f32_16x16x32_bf16 v[244:247], v[48:51], v[128:131], v[244:247]
    s_waitcnt lgkmcnt(7)
    ds_read_b64_tr_b16 v[70:71], v176 offset:6144
    v_mfma_f32_16x16x32_bf16 v[248:251], v[52:55], v[128:131], v[248:251]
    ds_read_b64_tr_b16 v[72:73], v177 offset:4096
    v_mfma_f32_16x16x32_bf16 v[228:231], v[52:55], v[124:127], v[228:231]
    s_waitcnt lgkmcnt(7)
    ds_read_b64_tr_b16 v[74:75], v177 offset:6144
    v_mfma_f32_16x16x32_bf16 v[232:235], v[56:59], v[124:127], v[232:235]
    ds_read_b64_tr_b16 v[76:77], v18 offset:1024
    v_mfma_f32_16x16x32_bf16 v[252:255], v[56:59], v[128:131], v[252:255]
    s_waitcnt vmcnt(11) lgkmcnt(7)
    ds_read_b64_tr_b16 v[78:79], v18 offset:1536
    v_mfma_f32_16x16x32_bf16 v[216:219], v[60:63], v[132:135], v[216:219]
    s_waitcnt vmcnt(10)
    ds_read_b64_tr_b16 v[80:81], v174 offset:10240
    buffer_load_dwordx4 v[124:127], v30, s[56:59], s6 offen offset:2048 sc1
    v_mfma_f32_16x16x32_bf16 v[236:239], v[60:63], v[136:139], v[236:239]
    s_waitcnt lgkmcnt(7)
    ds_read_b64_tr_b16 v[82:83], v174 offset:12288
    v_mfma_f32_16x16x32_bf16 v[240:243], v[64:67], v[136:139], v[240:243]
    ds_read_b64_tr_b16 v[84:85], v175 offset:10240
    v_mfma_f32_16x16x32_bf16 v[220:223], v[64:67], v[132:135], v[220:223]
    s_waitcnt lgkmcnt(7)
    ds_read_b64_tr_b16 v[86:87], v175 offset:12288
    v_mfma_f32_16x16x32_bf16 v[224:227], v[68:71], v[132:135], v[224:227]
    ds_read_b64_tr_b16 v[88:89], v176 offset:10240
    buffer_load_dwordx4 v[128:131], v30, s[56:59], s6 offen offset:3072 sc1
    v_mfma_f32_16x16x32_bf16 v[244:247], v[68:71], v[136:139], v[244:247]
    s_waitcnt lgkmcnt(7)
    ds_read_b64_tr_b16 v[90:91], v176 offset:12288
    v_mfma_f32_16x16x32_bf16 v[248:251], v[72:75], v[136:139], v[248:251]
    ds_read_b64_tr_b16 v[92:93], v177 offset:10240
    v_mfma_f32_16x16x32_bf16 v[228:231], v[72:75], v[132:135], v[228:231]
    s_waitcnt lgkmcnt(7)
    ds_read_b64_tr_b16 v[94:95], v177 offset:12288
    v_mfma_f32_16x16x32_bf16 v[232:235], v[76:79], v[132:135], v[232:235]
    ds_read_b64_tr_b16 v[96:97], v18 offset:10240
    v_mfma_f32_16x16x32_bf16 v[252:255], v[76:79], v[136:139], v[252:255]
    s_waitcnt vmcnt(11) lgkmcnt(7)
    ds_read_b64_tr_b16 v[98:99], v18 offset:10752
    s_add_u32 s6, s15, 36864
    v_mfma_f32_16x16x32_bf16 v[216:219], v[80:83], v[140:143], v[216:219]
    s_waitcnt vmcnt(10)
    ds_read_b64_tr_b16 v[40:41], v174 offset:14336
    buffer_load_dwordx4 v[132:135], v30, s[56:59], s6 offen offset:0 sc1
    v_mfma_f32_16x16x32_bf16 v[236:239], v[80:83], v[144:147], v[236:239]
    s_waitcnt lgkmcnt(7)
    ds_read_b32 v28, v33 offset:3136
    ds_read_b64_tr_b16 v[42:43], v174 offset:16384
    v_mfma_f32_16x16x32_bf16 v[240:243], v[84:87], v[144:147], v[240:243]
    ds_read_b64_tr_b16 v[44:45], v175 offset:14336
    v_mfma_f32_16x16x32_bf16 v[220:223], v[84:87], v[140:143], v[220:223]
    s_waitcnt lgkmcnt(8)
    ds_read_b64_tr_b16 v[46:47], v175 offset:16384
    v_mfma_f32_16x16x32_bf16 v[224:227], v[88:91], v[140:143], v[224:227]
    ds_read_b64_tr_b16 v[48:49], v176 offset:14336
    buffer_load_dwordx4 v[136:139], v30, s[56:59], s6 offen offset:1024 sc1
    v_mfma_f32_16x16x32_bf16 v[244:247], v[88:91], v[144:147], v[244:247]
    s_waitcnt lgkmcnt(8)
    ds_read_b64_tr_b16 v[50:51], v176 offset:16384
    v_mfma_f32_16x16x32_bf16 v[248:251], v[92:95], v[144:147], v[248:251]
    ds_read_b64_tr_b16 v[52:53], v177 offset:14336
    v_mfma_f32_16x16x32_bf16 v[228:231], v[92:95], v[140:143], v[228:231]
    s_waitcnt lgkmcnt(8)
    ds_read_b64_tr_b16 v[54:55], v177 offset:16384
    v_mfma_f32_16x16x32_bf16 v[232:235], v[96:99], v[140:143], v[232:235]
    ds_read_b64_tr_b16 v[56:57], v18 offset:11264
    v_mfma_f32_16x16x32_bf16 v[252:255], v[96:99], v[144:147], v[252:255]
    s_waitcnt vmcnt(11) lgkmcnt(7)
    v_cmp_gt_u32 vcc, 1, v28
    s_cbranch_vccnz L_slow_31
L_back_32:
    ds_read_b64_tr_b16 v[58:59], v18 offset:11776
    v_mfma_f32_16x16x32_bf16 v[216:219], v[40:43], v[148:151], v[216:219]
    s_waitcnt vmcnt(10)
    ds_read_b128 v[60:63], v19 offset:0
    buffer_load_dwordx4 v[140:143], v30, s[56:59], s6 offen offset:2048 sc1
    v_mfma_f32_16x16x32_bf16 v[236:239], v[40:43], v[152:155], v[236:239]
    s_waitcnt lgkmcnt(7)
    ds_read_b128 v[64:67], v19 offset:2048
    v_mfma_f32_16x16x32_bf16 v[240:243], v[44:47], v[152:155], v[240:243]
    ds_read_b128 v[68:71], v19 offset:4096
    v_mfma_f32_16x16x32_bf16 v[220:223], v[44:47], v[148:151], v[220:223]
    s_waitcnt lgkmcnt(7)
    ds_read_b128 v[72:75], v19 offset:6144
    v_mfma_f32_16x16x32_bf16 v[224:227], v[48:51], v[148:151], v[224:227]
    ds_read_b128 v[76:79], v19 offset:8192
    buffer_load_dwordx4 v[144:147], v30, s[56:59], s6 offen offset:3072 sc1
    v_mfma_f32_16x16x32_bf16 v[244:247], v[48:51], v[152:155], v[244:247]
    s_waitcnt lgkmcnt(7)
    ds_read_b128 v[80:83], v20 offset:0
    v_mfma_f32_16x16x32_bf16 v[248:251], v[52:55], v[152:155], v[248:251]
    ds_read_b128 v[84:87], v20 offset:2048
    v_mfma_f32_16x16x32_bf16 v[228:231], v[52:55], v[148:151], v[228:231]
    s_waitcnt lgkmcnt(7)
    ds_read_b128 v[88:91], v20 offset:4096
    v_mfma_f32_16x16x32_bf16 v[232:235], v[56:59], v[148:151], v[232:235]
    v_mov_b32 v34, 6
    ds_write_b32 v32, v34 offset:3072
    ds_read_b128 v[92:95], v20 offset:6144
    v_mfma_f32_16x16x32_bf16 v[252:255], v[56:59], v[152:155], v[252:255]
    s_waitcnt vmcnt(11) lgkmcnt(9)
    ds_read_b128 v[96:99], v20 offset:8192
    s_add_u32 s6, s15, 40960
    v_mfma_f32_16x16x32_bf16 v[216:219], v[60:63], v[100:103], v[216:219]
    s_waitcnt lgkmcnt(9)
    ds_read_b128 v[40:43], v19 offset:10240
    buffer_load_dwordx4 v[148:151], v30, s[56:59], s6 offen offset:0 sc1
    v_mfma_f32_16x16x32_bf16 v[220:223], v[64:67], v[100:103], v[220:223]
    s_waitcnt lgkmcnt(9)
    ds_read_b128 v[44:47], v19 offset:12288
    v_mfma_f32_16x16x32_bf16 v[224:227], v[68:71], v[100:103], v[224:227]
    s_waitcnt lgkmcnt(9)
    ds_read_b128 v[48:51], v19 offset:14336
    v_mfma_f32_16x16x32_bf16 v[228:231], v[72:75], v[100:103], v[228:231]
    s_waitcnt lgkmcnt(9)
    ds_read_b128 v[52:55], v19 offset:16384
    v_mfma_f32_16x16x32_bf16 v[232:235], v[76:79], v[100:103], v[232:235]
    s_waitcnt vmcnt(11) lgkmcnt(9)
    ds_read_b128 v[56:59], v19 offset:18432
    buffer_load_dwordx4 v[152:155], v30, s[56:59], s6 offen offset:1024 sc1
    v_mfma_f32_16x16x32_bf16 v[216:219], v[80:83], v[104:107], v[216:219]
    s_waitcnt lgkmcnt(9)
    ds_read_b128 v[60:63], v20 offset:10240
    v_mfma_f32_16x16x32_bf16 v[220:223], v[84:87], v[104:107], v[220:223]
    s_waitcnt lgkmcnt(9)
    ds_read_b128 v[64:67], v20 offset:12288
    v_mfma_f32_16x16x32_bf16 v[224:227], v[88:91], v[104:107], v[224:227]
    s_waitcnt lgkmcnt(8)
    ds_read_b128 v[68:71], v20 offset:14336
    v_mfma_f32_16x16x32_bf16 v[228:231], v[92:95], v[104:107], v[228:231]
    s_waitcnt lgkmcnt(8)
    ds_read_b128 v[72:75], v20 offset:16384
    buffer_load_dwordx4 v[100:103], v30, s[56:59], s6 offen offset:2048 sc1
    v_mfma_f32_16x16x32_bf16 v[232:235], v[96:99], v[104:107], v[232:235]
    s_waitcnt vmcnt(12) lgkmcnt(8)
    ds_read_b128 v[76:79], v20 offset:18432
    v_mfma_f32_16x16x32_bf16 v[216:219], v[40:43], v[108:111], v[216:219]
    s_waitcnt lgkmcnt(8)
    ds_read_b128 v[80:83], v19 offset:20480
    v_mfma_f32_16x16x32_bf16 v[220:223], v[44:47], v[108:111], v[220:223]
    s_waitcnt lgkmcnt(8)
    ds_read_b128 v[84:87], v19 offset:22528
    v_mfma_f32_16x16x32_bf16 v[224:227], v[48:51], v[108:111], v[224:227]
    s_waitcnt lgkmcnt(8)
    ds_read_b128 v[88:91], v19 offset:24576
    buffer_load_dwordx4 v[104:107], v30, s[56:59], s6 offen offset:3072 sc1
    v_mfma_f32_16x16x32_bf16 v[228:231], v[52:55], v[108:111], v[228:231]
    s_waitcnt lgkmcnt(8)
    ds_read_b128 v[92:95], v19 offset:26624
    v_mfma_f32_16x16x32_bf16 v[232:235], v[56:59], v[108:111], v[232:235]
    s_waitcnt vmcnt(12) lgkmcnt(8)
    ds_read_b128 v[96:99], v19 offset:28672
    v_mfma_f32_16x16x32_bf16 v[216:219], v[60:63], v[112:115], v[216:219]
    s_waitcnt lgkmcnt(8)
    ds_read_b128 v[40:43], v20 offset:20480
    s_add_u32 s6, s15, 45056
    v_mfma_f32_16x16x32_bf16 v[220:223], v[64:67], v[112:115], v[220:223]
    s_waitcnt lgkmcnt(8)
    ds_read_b128 v[44:47], v20 offset:22528
    buffer_load_dwordx4 v[108:111], v30, s[56:59], s6 offen offset:0 sc1
    v_mfma_f32_16x16x32_bf16 v[224:227], v[68:71], v[112:115], v[224:227]
    s_waitcnt lgkmcnt(8)
    ds_read_b128 v[48:51], v20 offset:24576
    v_mfma_f32_16x16x32_bf16 v[228:231], v[72:75], v[112:115], v[228:231]
    s_waitcnt lgkmcnt(8)
    ds_read_b128 v[52:55], v20 offset:26624
    v_mfma_f32_16x16x32_bf16 v[232:235], v[76:79], v[112:115], v[232:235]
    s_waitcnt vmcnt(12) lgkmcnt(8)
    ds_read_b128 v[56:59], v20 offset:28672
    v_mfma_f32_16x16x32_bf16 v[216:219], v[80:83], v[116:119], v[216:219]
    s_waitcnt lgkmcnt(8)
    ds_read_b128 v[60:63], v19 offset:30720
    buffer_load_dwordx4 v[112:115], v30, s[56:59], s6 offen offset:1024 sc1
    v_mfma_f32_16x16x32_bf16 v[220:223], v[84:87], v[116:119], v[220:223]
    s_waitcnt lgkmcnt(8)
    ds_read_b128 v[64:67], v19 offset:32768
    v_mfma_f32_16x16x32_bf16 v[224:227], v[88:91], v[116:119], v[224:227]
    s_waitcnt lgkmcnt(8)
    ds_read_b128 v[68:71], v19 offset:34816
    v_mfma_f32_16x16x32_bf16 v[228:231], v[92:95], v[116:119], v[228:231]
    s_waitcnt lgkmcnt(8)
    ds_read_b128 v[72:75], v19 offset:36864
    v_mfma_f32_16x16x32_bf16 v[232:235], v[96:99], v[116:119], v[232:235]
    s_waitcnt vmcnt(12) lgkmcnt(8)
    ds_read_b128 v[76:79], v19 offset:38912
    v_mfma_f32_16x16x32_bf16 v[216:219], v[40:43], v[120:123], v[216:219]
    s_waitcnt lgkmcnt(8)
    ds_read_b128 v[80:83], v20 offset:30720
    v_mfma_f32_16x16x32_bf16 v[220:223], v[44:47], v[120:123], v[220:223]
    s_waitcnt lgkmcnt(8)
    ds_read_b128 v[84:87], v20 offset:32768
    buffer_load_dwordx4 v[116:119], v30, s[56:59], s6 offen offset:2048 sc1
    v_mfma_f32_16x16x32_bf16 v[224:227], v[48:51], v[120:123], v[224:227]
    s_waitcnt lgkmcnt(8)
    ds_read_b128 v[88:91], v20 offset:34816
    v_mfma_f32_16x16x32_bf16 v[228:231], v[52:55], v[120:123], v[228:231]
    s_waitcnt lgkmcnt(8)
    ds_read_b128 v[92:95], v20 offset:36864
    v_mfma_f32_16x16x32_bf16 v[232:235], v[56:59], v[120:123], v[232:235]
    s_waitcnt vmcnt(12) lgkmcnt(8)
    ds_read_b128 v[96:99], v20 offset:38912
    v_mfma_f32_16x16x32_bf16 v[216:219], v[60:63], v[124:127], v[216:219]
    s_waitcnt lgkmcnt(8)
    ds_read_b128 v[40:43], v19 offset:40960
    buffer_load_dwordx4 v[120:123], v30, s[56:59], s6 offen offset:3072 sc1
    v_mfma_f32_16x16x32_bf16 v[220:223], v[64:67], v[124:127], v[220:223]
    s_waitcnt lgkmcnt(8)
    ds_read_b128 v[44:47], v19 offset:43008
    v_mfma_f32_16x16x32_bf16 v[224:227], v[68:71], v[124:127], v[224:227]
    s_waitcnt lgkmcnt(8)
    ds_read_b128 v[48:51], v19 offset:45056
    v_mfma_f32_16x16x32_bf16 v[228:231], v[72:75], v[124:127], v[228:231]
    s_waitcnt lgkmcnt(8)
    ds_read_b128 v[52:55], v19 offset:47104
    v_mfma_f32_16x16x32_bf16 v[232:235], v[76:79], v[124:127], v[232:235]
    s_waitcnt vmcnt(12) lgkmcnt(8)
    ds_read_b128 v[56:59], v19 offset:49152
    v_mfma_f32_16x16x32_bf16 v[216:219], v[80:83], v[128:131], v[216:219]
    s_waitcnt lgkmcnt(8)
    ds_read_b128 v[60:63], v20 offset:40960
    s_add_u32 s6, s15, 28672
    v_mfma_f32_16x16x32_bf16 v[220:223], v[84:87], v[128:131], v[220:223]
    s_waitcnt lgkmcnt(8)
    ds_read_b128 v[64:67], v20 offset:43008
    buffer_load_dwordx4 v[124:127], v31, s[56:59], s6 offen offset:0 sc1
    v_mfma_f32_16x16x32_bf16 v[224:227], v[88:91], v[128:131], v[224:227]
    s_waitcnt lgkmcnt(8)
    ds_read_b128 v[68:71], v20 offset:45056
    v_mfma_f32_16x16x32_bf16 v[228:231], v[92:95], v[128:131], v[228:231]
    s_waitcnt lgkmcnt(8)
    ds_read_b128 v[72:75], v20 offset:47104
    v_mfma_f32_16x16x32_bf16 v[232:235], v[96:99], v[128:131], v[232:235]
    s_waitcnt vmcnt(12) lgkmcnt(8)
    ds_read_b128 v[76:79], v20 offset:49152
    v_mfma_f32_16x16x32_bf16 v[216:219], v[40:43], v[132:135], v[216:219]
    s_waitcnt lgkmcnt(8)
    ds_read_b128 v[80:83], v19 offset:51200
    buffer_load_dwordx4 v[128:131], v31, s[56:59], s6 offen offset:1024 sc1
    v_mfma_f32_16x16x32_bf16 v[220:223], v[44:47], v[132:135], v[220:223]
    s_waitcnt lgkmcnt(8)
    ds_read_b32 v29, v33 offset:3136
    ds_read_b128 v[84:87], v19 offset:53248
    v_mfma_f32_16x16x32_bf16 v[224:227], v[48:51], v[132:135], v[224:227]
    s_waitcnt lgkmcnt(9)
    ds_read_b128 v[88:91], v19 offset:55296
    v_mfma_f32_16x16x32_bf16 v[228:231], v[52:55], v[132:135], v[228:231]
    s_waitcnt lgkmcnt(9)
    ds_read_b128 v[92:95], v19 offset:57344
    v_mfma_f32_16x16x32_bf16 v[232:235], v[56:59], v[132:135], v[232:235]
    s_waitcnt vmcnt(12) lgkmcnt(9)
    ds_read_b128 v[96:99], v19 offset:59392
    v_mfma_f32_16x16x32_bf16 v[216:219], v[60:63], v[136:139], v[216:219]
    s_waitcnt lgkmcnt(9)
    ds_read_b128 v[40:43], v20 offset:51200
    v_mfma_f32_16x16x32_bf16 v[220:223], v[64:67], v[136:139], v[220:223]
    s_waitcnt lgkmcnt(9)
    ds_read_b128 v[44:47], v20 offset:53248
    buffer_load_dwordx4 v[132:135], v31, s[56:59], s6 offen offset:2048 sc1
    v_mfma_f32_16x16x32_bf16 v[224:227], v[68:71], v[136:139], v[224:227]
    s_waitcnt lgkmcnt(9)
    ds_read_b128 v[48:51], v20 offset:55296
    v_mfma_f32_16x16x32_bf16 v[228:231], v[72:75], v[136:139], v[228:231]
    s_waitcnt lgkmcnt(9)
    ds_read_b128 v[52:55], v20 offset:57344
    v_mfma_f32_16x16x32_bf16 v[232:235], v[76:79], v[136:139], v[232:235]
    s_waitcnt vmcnt(12) lgkmcnt(9)
    s_waitcnt lgkmcnt(8)
    v_cmp_gt_u32 vcc, 2, v29
    s_cbranch_vccnz L_slow_33
L_back_34:
    ds_read_b128 v[56:59], v20 offset:59392
    v_mfma_f32_16x16x32_bf16 v[216:219], v[80:83], v[140:143], v[216:219]
    s_waitcnt lgkmcnt(8)
    ds_read_b128 v[60:63], v21 offset:0
    buffer_load_dwordx4 v[136:139], v31, s[56:59], s6 offen offset:3072 sc1
    v_mfma_f32_16x16x32_bf16 v[220:223], v[84:87], v[140:143], v[220:223]
    s_waitcnt lgkmcnt(8)
    ds_read_b128 v[64:67], v21 offset:2048
    v_mfma_f32_16x16x32_bf16 v[224:227], v[88:91], v[140:143], v[224:227]
    s_waitcnt lgkmcnt(8)
    ds_read_b128 v[68:71], v21 offset:4096
    v_mfma_f32_16x16x32_bf16 v[228:231], v[92:95], v[140:143], v[228:231]
    s_waitcnt lgkmcnt(8)
    ds_read_b128 v[72:75], v21 offset:6144
    v_mfma_f32_16x16x32_bf16 v[232:235], v[96:99], v[140:143], v[232:235]
    s_waitcnt vmcnt(12) lgkmcnt(8)
    ds_read_b128 v[76:79], v21 offset:8192
    v_mfma_f32_16x16x32_bf16 v[216:219], v[40:43], v[144:147], v[216:219]
    s_waitcnt lgkmcnt(8)
    ds_read_b128 v[80:83], v22 offset:0
    s_add_u32 s6, s15, 32768
    v_mfma_f32_16x16x32_bf16 v[220:223], v[44:47], v[144:147], v[220:223]
    s_waitcnt lgkmcnt(8)
    ds_read_b128 v[84:87], v22 offset:2048
    buffer_load_dwordx4 v[140:143], v31, s[56:59], s6 offen offset:0 sc1
    v_mfma_f32_16x16x32_bf16 v[224:227], v[48:51], v[144:147], v[224:227]
    s_waitcnt lgkmcnt(8)
    ds_read_b128 v[88:91], v22 offset:4096
    v_mfma_f32_16x16x32_bf16 v[228:231], v[52:55], v[144:147], v[228:231]
    s_waitcnt lgkmcnt(8)
    ds_read_b128 v[92:95], v22 offset:6144
    v_mfma_f32_16x16x32_bf16 v[232:235], v[56:59], v[144:147], v[232:235]
    s_waitcnt vmcnt(12) lgkmcnt(8)
    ds_read_b128 v[96:99], v22 offset:8192
    v_mfma_f32_16x16x32_bf16 v[216:219], v[60:63], v[148:151], v[216:219]
    s_waitcnt lgkmcnt(8)
    ds_read_b128 v[40:43], v21 offset:10240
    buffer_load_dwordx4 v[144:147], v31, s[56:59], s6 offen offset:1024 sc1
    v_mfma_f32_16x16x32_bf16 v[220:223], v[64:67], v[148:151], v[220:223]
    s_waitcnt lgkmcnt(8)
    ds_read_b128 v[44:47], v21 offset:12288
    v_mfma_f32_16x16x32_bf16 v[224:227], v[68:71], v[148:151], v[224:227]
    s_waitcnt lgkmcnt(8)
    ds_read_b128 v[48:51], v21 offset:14336
    v_mfma_f32_16x16x32_bf16 v[228:231], v[72:75], v[148:151], v[228:231]
    s_waitcnt lgkmcnt(8)
    ds_read_b128 v[52:55], v21 offset:16384
    v_mfma_f32_16x16x32_bf16 v[232:235], v[76:79], v[148:151], v[232:235]
    s_waitcnt vmcnt(12) lgkmcnt(8)
    ds_read_b128 v[56:59], v21 offset:18432
    v_mfma_f32_16x16x32_bf16 v[216:219], v[80:83], v[152:155], v[216:219]
    s_waitcnt lgkmcnt(8)
    ds_read_b128 v[60:63], v22 offset:10240
    v_mfma_f32_16x16x32_bf16 v[220:223], v[84:87], v[152:155], v[220:223]
    s_waitcnt lgkmcnt(8)
    ds_read_b128 v[64:67], v22 offset:12288
    buffer_load_dwordx4 v[148:151], v31, s[56:59], s6 offen offset:2048 sc1
    v_mfma_f32_16x16x32_bf16 v[224:227], v[88:91], v[152:155], v[224:227]
    s_waitcnt lgkmcnt(8)
    ds_read_b128 v[68:71], v22 offset:14336
    v_mfma_f32_16x16x32_bf16 v[228:231], v[92:95], v[152:155], v[228:231]
    s_waitcnt lgkmcnt(8)
    ds_read_b128 v[72:75], v22 offset:16384
    v_mfma_f32_16x16x32_bf16 v[232:235], v[96:99], v[152:155], v[232:235]
    s_waitcnt vmcnt(12) lgkmcnt(8)
    ds_read_b128 v[76:79], v22 offset:18432
    v_mfma_f32_16x16x32_bf16 v[216:219], v[40:43], v[100:103], v[216:219]
    s_waitcnt lgkmcnt(8)
    ds_read_b128 v[80:83], v21 offset:20480
    buffer_load_dwordx4 v[152:155], v31, s[56:59], s6 offen offset:3072 sc1
    v_mfma_f32_16x16x32_bf16 v[220:223], v[44:47], v[100:103], v[220:223]
    s_waitcnt lgkmcnt(8)
    ds_read_b128 v[84:87], v21 offset:22528
    v_mfma_f32_16x16x32_bf16 v[224:227], v[48:51], v[100:103], v[224:227]
    s_waitcnt lgkmcnt(8)
    ds_read_b128 v[88:91], v21 offset:24576
    v_mfma_f32_16x16x32_bf16 v[228:231], v[52:55], v[100:103], v[228:231]
    s_waitcnt lgkmcnt(8)
    ds_read_b128 v[92:95], v21 offset:26624
    v_mfma_f32_16x16x32_bf16 v[232:235], v[56:59], v[100:103], v[232:235]
    s_waitcnt vmcnt(12) lgkmcnt(8)
    ds_read_b128 v[96:99], v21 offset:28672
    v_mfma_f32_16x16x32_bf16 v[216:219], v[60:63], v[104:107], v[216:219]
    s_waitcnt lgkmcnt(8)
    ds_read_b128 v[40:43], v22 offset:20480
    s_add_u32 s6, s15, 36864
    v_mfma_f32_16x16x32_bf16 v[220:223], v[64:67], v[104:107], v[220:223]
    s_waitcnt lgkmcnt(8)
    ds_read_b128 v[44:47], v22 offset:22528
    buffer_load_dwordx4 v[100:103], v31, s[56:59], s6 offen offset:0 sc1
    v_mfma_f32_16x16x32_bf16 v[224:227], v[68:71], v[104:107], v[224:227]
    s_waitcnt lgkmcnt(8)
    ds_read_b128 v[48:51], v22 offset:24576
    v_mfma_f32_16x16x32_bf16 v[228:231], v[72:75], v[104:107], v[228:231]
    s_waitcnt lgkmcnt(8)
    ds_read_b128 v[52:55], v22 offset:26624
    v_mfma_f32_16x16x32_bf16 v[232:235], v[76:79], v[104:107], v[232:235]
    s_waitcnt vmcnt(12) lgkmcnt(8)
    ds_read_b128 v[56:59], v22 offset:28672
    v_mfma_f32_16x16x32_bf16 v[216:219], v[80:83], v[108:111], v[216:219]
    s_waitcnt lgkmcnt(8)
    ds_read_b128 v[60:63], v21 offset:30720
    buffer_load_dwordx4 v[104:107], v31, s[56:59], s6 offen offset:1024 sc1
    v_mfma_f32_16x16x32_bf16 v[220:223], v[84:87], v[108:111], v[220:223]
    s_waitcnt lgkmcnt(8)
    ds_read_b32 v28, v33 offset:3072
    ds_read_b128 v[64:67], v21 offset:32768
    v_mfma_f32_16x16x32_bf16 v[224:227], v[88:91], v[108:111], v[224:227]
    s_waitcnt lgkmcnt(9)
    ds_read_b128 v[68:71], v21 offset:34816
    v_mfma_f32_16x16x32_bf16 v[228:231], v[92:95], v[108:111], v[228:231]
    s_waitcnt lgkmcnt(9)
    ds_read_b128 v[72:75], v21 offset:36864
    v_mfma_f32_16x16x32_bf16 v[232:235], v[96:99], v[108:111], v[232:235]
    s_waitcnt vmcnt(12) lgkmcnt(9)
    ds_read_b128 v[76:79], v21 offset:38912
    v_mfma_f32_16x16x32_bf16 v[216:219], v[40:43], v[112:115], v[216:219]
    s_waitcnt lgkmcnt(9)
    ds_read_b128 v[80:83], v22 offset:30720
    v_mfma_f32_16x16x32_bf16 v[220:223], v[44:47], v[112:115], v[220:223]
    s_waitcnt lgkmcnt(9)
    ds_read_b128 v[84:87], v22 offset:32768
    buffer_load_dwordx4 v[108:111], v31, s[56:59], s6 offen offset:2048 sc1
    v_mfma_f32_16x16x32_bf16 v[224:227], v[48:51], v[112:115], v[224:227]
    s_waitcnt lgkmcnt(9)
    ds_read_b128 v[88:91], v22 offset:34816
    v_mfma_f32_16x16x32_bf16 v[228:231], v[52:55], v[112:115], v[228:231]
    s_waitcnt lgkmcnt(9)
    ds_read_b128 v[92:95], v22 offset:36864
    v_mfma_f32_16x16x32_bf16 v[232:235], v[56:59], v[112:115], v[232:235]
    s_waitcnt vmcnt(12) lgkmcnt(9)
    s_waitcnt lgkmcnt(8)
    v_cmp_gt_u32 vcc, 6, v28
    s_cbranch_vccnz L_slow_35
L_back_36:
    ds_read_b128 v[96:99], v22 offset:38912
    v_mfma_f32_16x16x32_bf16 v[216:219], v[60:63], v[116:119], v[216:219]
    s_waitcnt lgkmcnt(8)
    ds_read_b128 v[40:43], v19 offset:0
    buffer_load_dwordx4 v[112:115], v31, s[56:59], s6 offen offset:3072 sc1
    v_mfma_f32_16x16x32_bf16 v[220:223], v[64:67], v[116:119], v[220:223]
    s_waitcnt lgkmcnt(8)
    ds_read_b128 v[44:47], v19 offset:2048
    v_mfma_f32_16x16x32_bf16 v[224:227], v[68:71], v[116:119], v[224:227]
    s_waitcnt lgkmcnt(8)
    ds_read_b128 v[48:51], v19 offset:4096
    v_mfma_f32_16x16x32_bf16 v[228:231], v[72:75], v[116:119], v[228:231]
    s_waitcnt lgkmcnt(8)
    ds_read_b128 v[52:55], v19 offset:6144
    v_mfma_f32_16x16x32_bf16 v[232:235], v[76:79], v[116:119], v[232:235]
    s_waitcnt vmcnt(12) lgkmcnt(8)
    ds_read_b128 v[56:59], v19 offset:8192
    v_mfma_f32_16x16x32_bf16 v[216:219], v[80:83], v[120:123], v[216:219]
    s_waitcnt lgkmcnt(8)
    ds_read_b128 v[60:63], v20 offset:0
    s_add_u32 s6, s15, 40960
    v_mfma_f32_16x16x32_bf16 v[220:223], v[84:87], v[120:123], v[220:223]
    s_waitcnt lgkmcnt(8)
    ds_read_b128 v[64:67], v20 offset:2048
    buffer_load_dwordx4 v[116:119], v31, s[56:59], s6 offen offset:0 sc1
    v_mfma_f32_16x16x32_bf16 v[224:227], v[88:91], v[120:123], v[224:227]
    s_waitcnt lgkmcnt(8)
    ds_read_b128 v[68:71], v20 offset:4096
    v_mfma_f32_16x16x32_bf16 v[228:231], v[92:95], v[120:123], v[228:231]
    s_waitcnt lgkmcnt(8)
    ds_read_b128 v[72:75], v20 offset:6144
    v_mfma_f32_16x16x32_bf16 v[232:235], v[96:99], v[120:123], v[232:235]
    s_waitcnt vmcnt(12) lgkmcnt(8)
    ds_read_b128 v[76:79], v20 offset:8192
    v_cvt_pk_bf16_f32 v204, v216, v217
    v_cvt_pk_bf16_f32 v205, v218, v219
    v_mfma_f32_16x16x32_bf16 v[236:239], v[40:43], v[124:127], v[236:239]
    s_waitcnt lgkmcnt(8)
    ds_read_b128 v[80:83], v19 offset:10240
    buffer_load_dwordx4 v[120:123], v31, s[56:59], s6 offen offset:1024 sc1
    v_cvt_pk_bf16_f32 v206, v220, v221
    v_cvt_pk_bf16_f32 v208, v222, v223
    v_mfma_f32_16x16x32_bf16 v[240:243], v[44:47], v[124:127], v[240:243]
    s_waitcnt lgkmcnt(8)
    ds_read_b128 v[84:87], v19 offset:12288
    v_cvt_pk_bf16_f32 v209, v224, v225
    v_cvt_pk_bf16_f32 v210, v226, v227
    v_mfma_f32_16x16x32_bf16 v[244:247], v[48:51], v[124:127], v[244:247]
    s_waitcnt lgkmcnt(8)
    ds_read_b128 v[88:91], v19 offset:14336
    v_cvt_pk_bf16_f32 v212, v228, v229
    v_cvt_pk_bf16_f32 v213, v230, v231
    v_mfma_f32_16x16x32_bf16 v[248:251], v[52:55], v[124:127], v[248:251]
    s_waitcnt lgkmcnt(8)
    ds_read_b128 v[92:95], v19 offset:16384
    v_cvt_pk_bf16_f32 v214, v232, v233
    v_cvt_pk_bf16_f32 v202, v234, v235
    v_mfma_f32_16x16x32_bf16 v[252:255], v[56:59], v[124:127], v[252:255]
    s_waitcnt vmcnt(12) lgkmcnt(8)
    ds_read_b128 v[96:99], v19 offset:18432
    v_lshl_or_b32 v207, v202, 16, s62
    buffer_store_dwordx4 v[204:207], v15, s[56:59], s60 offen offset:0 sc1
    v_mfma_f32_16x16x32_bf16 v[236:239], v[60:63], v[128:131], v[236:239]
    s_waitcnt lgkmcnt(8)
    ds_read_b128 v[40:43], v20 offset:10240
    v_and_b32 v202, s63, v202
    v_or_b32_e64 v211, s62, v202
    v_mfma_f32_16x16x32_bf16 v[240:243], v[64:67], v[128:131], v[240:243]
    s_waitcnt lgkmcnt(8)
    ds_read_b128 v[44:47], v20 offset:12288
    buffer_load_dwordx4 v[124:127], v31, s[56:59], s6 offen offset:2048 sc1
    buffer_store_dwordx4 v[208:211], v15, s[56:59], s60 offen offset:1024 sc1
    buffer_store_dwordx4 v[212:215], v15, s[56:59], s60 offen offset:2048 sc1
    v_mfma_f32_16x16x32_bf16 v[244:247], v[68:71], v[128:131], v[244:247]
    s_waitcnt lgkmcnt(8)
    ds_read_b128 v[48:51], v20 offset:14336
    v_mfma_f32_16x16x32_bf16 v[248:251], v[72:75], v[128:131], v[248:251]
    s_waitcnt lgkmcnt(8)
    ds_read_b128 v[52:55], v20 offset:16384
    v_mfma_f32_16x16x32_bf16 v[252:255], v[76:79], v[128:131], v[252:255]
    s_waitcnt vmcnt(15) lgkmcnt(8)
    ds_read_b128 v[56:59], v20 offset:18432
    v_mfma_f32_16x16x32_bf16 v[236:239], v[80:83], v[132:135], v[236:239]
    s_waitcnt lgkmcnt(8)
    ds_read_b128 v[60:63], v19 offset:20480
    buffer_load_dwordx4 v[128:131], v31, s[56:59], s6 offen offset:3072 sc1
    v_mfma_f32_16x16x32_bf16 v[240:243], v[84:87], v[132:135], v[240:243]
    s_waitcnt lgkmcnt(8)
    ds_read_b128 v[64:67], v19 offset:22528
    v_mfma_f32_16x16x32_bf16 v[244:247], v[88:91], v[132:135], v[244:247]
    s_waitcnt lgkmcnt(8)
    ds_read_b128 v[68:71], v19 offset:24576
    v_mfma_f32_16x16x32_bf16 v[248:251], v[92:95], v[132:135], v[248:251]
    s_waitcnt lgkmcnt(8)
    ds_read_b128 v[72:75], v19 offset:26624
    v_mfma_f32_16x16x32_bf16 v[252:255], v[96:99], v[132:135], v[252:255]
    s_waitcnt vmcnt(15) lgkmcnt(8)
    ds_read_b128 v[76:79], v19 offset:28672
    v_mfma_f32_16x16x32_bf16 v[236:239], v[40:43], v[136:139], v[236:239]
    s_waitcnt lgkmcnt(8)
    ds_read_b128 v[80:83], v20 offset:20480
    s_add_u32 s6, s15, 45056
    v_mfma_f32_16x16x32_bf16 v[240:243], v[44:47], v[136:139], v[240:243]
    s_waitcnt lgkmcnt(8)
    ds_read_b128 v[84:87], v20 offset:22528
    buffer_load_dwordx4 v[132:135], v31, s[56:59], s6 offen offset:0 sc1
    v_mfma_f32_16x16x32_bf16 v[244:247], v[48:51], v[136:139], v[244:247]
    s_waitcnt lgkmcnt(8)
    ds_read_b128 v[88:91], v20 offset:24576
    v_mfma_f32_16x16x32_bf16 v[248:251], v[52:55], v[136:139], v[248:251]
    s_waitcnt lgkmcnt(8)
    ds_read_b128 v[92:95], v20 offset:26624
    v_mfma_f32_16x16x32_bf16 v[252:255], v[56:59], v[136:139], v[252:255]
    s_waitcnt vmcnt(15) lgkmcnt(8)
    ds_read_b128 v[96:99], v20 offset:28672
    v_mfma_f32_16x16x32_bf16 v[236:239], v[60:63], v[140:143], v[236:239]
    s_waitcnt lgkmcnt(8)
    ds_read_b128 v[40:43], v19 offset:30720
    buffer_load_dwordx4 v[136:139], v31, s[56:59], s6 offen offset:1024 sc1
    v_mfma_f32_16x16x32_bf16 v[240:243], v[64:67], v[140:143], v[240:243]
    s_waitcnt lgkmcnt(8)
    ds_read_b128 v[44:47], v19 offset:32768
    v_mfma_f32_16x16x32_bf16 v[244:247], v[68:71], v[140:143], v[244:247]
    s_waitcnt lgkmcnt(8)
    ds_read_b128 v[48:51], v19 offset:34816
    v_mfma_f32_16x16x32_bf16 v[248:251], v[72:75], v[140:143], v[248:251]
    s_waitcnt lgkmcnt(8)
    ds_read_b128 v[52:55], v19 offset:36864
    v_mfma_f32_16x16x32_bf16 v[252:255], v[76:79], v[140:143], v[252:255]
    s_waitcnt vmcnt(15) lgkmcnt(8)
    ds_read_b128 v[56:59], v19 offset:38912
    v_mfma_f32_16x16x32_bf16 v[236:239], v[80:83], v[144:147], v[236:239]
    s_waitcnt lgkmcnt(8)
    ds_read_b128 v[60:63], v20 offset:30720
    v_mfma_f32_16x16x32_bf16 v[240:243], v[84:87], v[144:147], v[240:243]
    s_waitcnt lgkmcnt(8)
    ds_read_b128 v[64:67], v20 offset:32768
    buffer_load_dwordx4 v[140:143], v31, s[56:59], s6 offen offset:2048 sc1
    v_mfma_f32_16x16x32_bf16 v[244:247], v[88:91], v[144:147], v[244:247]
    s_waitcnt lgkmcnt(8)
    ds_read_b128 v[68:71], v20 offset:34816
    v_mfma_f32_16x16x32_bf16 v[248:251], v[92:95], v[144:147], v[248:251]
    s_waitcnt lgkmcnt(8)
    ds_read_b128 v[72:75], v20 offset:36864
    v_mfma_f32_16x16x32_bf16 v[252:255], v[96:99], v[144:147], v[252:255]
    s_waitcnt vmcnt(15) lgkmcnt(8)
    ds_read_b128 v[76:79], v20 offset:38912
    v_mfma_f32_16x16x32_bf16 v[236:239], v[40:43], v[148:151], v[236:239]
    s_waitcnt lgkmcnt(8)
    ds_read_b128 v[80:83], v19 offset:40960
    buffer_load_dwordx4 v[144:147], v31, s[56:59], s6 offen offset:3072 sc1
    v_mfma_f32_16x16x32_bf16 v[240:243], v[44:47], v[148:151], v[240:243]
    s_waitcnt lgkmcnt(8)
    ds_read_b128 v[84:87], v19 offset:43008
    v_mfma_f32_16x16x32_bf16 v[244:247], v[48:51], v[148:151], v[244:247]
    s_waitcnt lgkmcnt(8)
    ds_read_b128 v[88:91], v19 offset:45056
    v_mfma_f32_16x16x32_bf16 v[248:251], v[52:55], v[148:151], v[248:251]
    s_waitcnt lgkmcnt(8)
    ds_read_b128 v[92:95], v19 offset:47104
    v_mfma_f32_16x16x32_bf16 v[252:255], v[56:59], v[148:151], v[252:255]
    s_waitcnt vmcnt(15) lgkmcnt(8)
    ds_read_b128 v[96:99], v19 offset:49152
    v_mfma_f32_16x16x32_bf16 v[236:239], v[60:63], v[152:155], v[236:239]
    s_waitcnt lgkmcnt(8)
    ds_read_b128 v[40:43], v20 offset:40960
    v_mfma_f32_16x16x32_bf16 v[240:243], v[64:67], v[152:155], v[240:243]
    s_waitcnt lgkmcnt(8)
    ds_read_b128 v[44:47], v20 offset:43008
    v_mfma_f32_16x16x32_bf16 v[244:247], v[68:71], v[152:155], v[244:247]
    s_waitcnt lgkmcnt(8)
    ds_read_b128 v[48:51], v20 offset:45056
    v_mfma_f32_16x16x32_bf16 v[248:251], v[72:75], v[152:155], v[248:251]
    s_waitcnt lgkmcnt(8)
    ds_read_b128 v[52:55], v20 offset:47104
    v_mfma_f32_16x16x32_bf16 v[252:255], v[76:79], v[152:155], v[252:255]
    s_waitcnt vmcnt(14) lgkmcnt(8)
    ds_read_b128 v[56:59], v20 offset:49152
    v_mfma_f32_16x16x32_bf16 v[236:239], v[80:83], v[100:103], v[236:239]
    s_waitcnt lgkmcnt(8)
    ds_read_b128 v[60:63], v19 offset:51200
    v_mfma_f32_16x16x32_bf16 v[240:243], v[84:87], v[100:103], v[240:243]
    s_waitcnt lgkmcnt(8)
    ds_read_b128 v[64:67], v19 offset:53248
    v_mfma_f32_16x16x32_bf16 v[244:247], v[88:91], v[100:103], v[244:247]
    s_waitcnt lgkmcnt(8)
    ds_read_b128 v[68:71], v19 offset:55296
    v_mfma_f32_16x16x32_bf16 v[248:251], v[92:95], v[100:103], v[248:251]
    s_waitcnt lgkmcnt(8)
    ds_read_b128 v[72:75], v19 offset:57344
    v_mfma_f32_16x16x32_bf16 v[252:255], v[96:99], v[100:103], v[252:255]
    s_waitcnt vmcnt(13) lgkmcnt(8)
    ds_read_b128 v[76:79], v19 offset:59392
    v_mfma_f32_16x16x32_bf16 v[236:239], v[40:43], v[104:107], v[236:239]
    s_waitcnt lgkmcnt(8)
    ds_read_b128 v[80:83], v20 offset:51200
    v_mfma_f32_16x16x32_bf16 v[240:243], v[44:47], v[104:107], v[240:243]
    s_waitcnt lgkmcnt(8)
    ds_read_b128 v[84:87], v20 offset:53248
    v_mfma_f32_16x16x32_bf16 v[244:247], v[48:51], v[104:107], v[244:247]
    s_waitcnt lgkmcnt(8)
    ds_read_b128 v[88:91], v20 offset:55296
    v_mfma_f32_16x16x32_bf16 v[248:251], v[52:55], v[104:107], v[248:251]
    s_waitcnt lgkmcnt(8)
    ds_read_b128 v[92:95], v20 offset:57344
    v_mfma_f32_16x16x32_bf16 v[252:255], v[56:59], v[104:107], v[252:255]
    s_waitcnt vmcnt(12) lgkmcnt(8)
    ds_read_b128 v[96:99], v20 offset:59392
    v_mfma_f32_16x16x32_bf16 v[236:239], v[60:63], v[108:111], v[236:239]
    s_waitcnt lgkmcnt(8)
    ds_read_b128 v[40:43], v21 offset:0
    v_mfma_f32_16x16x32_bf16 v[240:243], v[64:67], v[108:111], v[240:243]
    s_waitcnt lgkmcnt(8)
    ds_read_b128 v[44:47], v21 offset:2048
    v_mfma_f32_16x16x32_bf16 v[244:247], v[68:71], v[108:111], v[244:247]
    s_waitcnt lgkmcnt(8)
    ds_read_b128 v[48:51], v21 offset:4096
    v_mfma_f32_16x16x32_bf16 v[248:251], v[72:75], v[108:111], v[248:251]
    s_waitcnt lgkmcnt(8)
    ds_read_b128 v[52:55], v21 offset:6144
    v_mfma_f32_16x16x32_bf16 v[252:255], v[76:79], v[108:111], v[252:255]
    s_waitcnt vmcnt(11) lgkmcnt(8)
    ds_read_b32 v23, v32 offset:3152
    ds_read_b128 v[56:59], v21 offset:8192
    v_mfma_f32_16x16x32_bf16 v[236:239], v[80:83], v[112:115], v[236:239]
    s_waitcnt lgkmcnt(9)
    ds_read_b128 v[60:63], v22 offset:0
    v_mfma_f32_16x16x32_bf16 v[240:243], v[84:87], v[112:115], v[240:243]
    s_waitcnt lgkmcnt(9)
    ds_read_b128 v[64:67], v22 offset:2048
    v_mfma_f32_16x16x32_bf16 v[244:247], v[88:91], v[112:115], v[244:247]
    s_waitcnt lgkmcnt(9)
    ds_read_b128 v[68:71], v22 offset:4096
    v_mfma_f32_16x16x32_bf16 v[248:251], v[92:95], v[112:115], v[248:251]
    s_waitcnt lgkmcnt(9)
    ds_read_b128 v[72:75], v22 offset:6144
    v_mfma_f32_16x16x32_bf16 v[252:255], v[96:99], v[112:115], v[252:255]
    s_waitcnt vmcnt(10) lgkmcnt(9)
    ds_read_b128 v[76:79], v22 offset:8192
    v_mfma_f32_16x16x32_bf16 v[236:239], v[40:43], v[116:119], v[236:239]
    s_waitcnt lgkmcnt(9)
    ds_read_b128 v[80:83], v21 offset:10240
    v_mfma_f32_16x16x32_bf16 v[240:243], v[44:47], v[116:119], v[240:243]
    s_waitcnt lgkmcnt(9)
    ds_read_b128 v[84:87], v21 offset:12288
    v_mfma_f32_16x16x32_bf16 v[244:247], v[48:51], v[116:119], v[244:247]
    s_waitcnt lgkmcnt(9)
    s_waitcnt lgkmcnt(8)
    v_cmp_gt_u32 vcc, 1, v23
    s_cbranch_vccnz L_slow_37
L_back_38:
    buffer_load_dwordx4 v[216:219], v15, s[56:59], s61 offen offset:0 sc1
    buffer_load_dwordx4 v[220:223], v15, s[56:59], s61 offen offset:1024 sc1
    buffer_load_dwordx4 v[224:227], v15, s[56:59], s61 offen offset:2048 sc1
    ds_read_b128 v[88:91], v21 offset:14336
    v_mfma_f32_16x16x32_bf16 v[248:251], v[52:55], v[116:119], v[248:251]
    s_waitcnt lgkmcnt(8)
    ds_read_b128 v[92:95], v21 offset:16384
    v_mfma_f32_16x16x32_bf16 v[252:255], v[56:59], v[116:119], v[252:255]
    s_waitcnt vmcnt(12) lgkmcnt(8)
    ds_read_b128 v[96:99], v21 offset:18432
    v_mfma_f32_16x16x32_bf16 v[236:239], v[60:63], v[120:123], v[236:239]
    s_waitcnt lgkmcnt(8)
    ds_read_b128 v[40:43], v22 offset:10240
    v_mfma_f32_16x16x32_bf16 v[240:243], v[64:67], v[120:123], v[240:243]
    s_waitcnt lgkmcnt(8)
    ds_read_b128 v[44:47], v22 offset:12288
    v_mfma_f32_16x16x32_bf16 v[244:247], v[68:71], v[120:123], v[244:247]
    s_waitcnt lgkmcnt(8)
    ds_read_b128 v[48:51], v22 offset:14336
    v_mfma_f32_16x16x32_bf16 v[248:251], v[72:75], v[120:123], v[248:251]
    s_waitcnt lgkmcnt(8)
    ds_read_b128 v[52:55], v22 offset:16384
    v_mfma_f32_16x16x32_bf16 v[252:255], v[76:79], v[120:123], v[252:255]
    s_waitcnt vmcnt(10) lgkmcnt(8)
    ds_read_b128 v[56:59], v22 offset:18432
    v_mfma_f32_16x16x32_bf16 v[236:239], v[80:83], v[124:127], v[236:239]
    s_waitcnt lgkmcnt(8)
    ds_read_b128 v[60:63], v21 offset:20480
    v_mfma_f32_16x16x32_bf16 v[240:243], v[84:87], v[124:127], v[240:243]
    s_waitcnt lgkmcnt(8)
    ds_read_b128 v[64:67], v21 offset:22528
    v_mfma_f32_16x16x32_bf16 v[244:247], v[88:91], v[124:127], v[244:247]
    s_waitcnt lgkmcnt(8)
    ds_read_b128 v[68:71], v21 offset:24576
    v_mfma_f32_16x16x32_bf16 v[248:251], v[92:95], v[124:127], v[248:251]
    s_waitcnt lgkmcnt(8)
    ds_read_b128 v[72:75], v21 offset:26624
    v_mfma_f32_16x16x32_bf16 v[252:255], v[96:99], v[124:127], v[252:255]
    s_waitcnt vmcnt(7) lgkmcnt(8)
    ds_read_b128 v[76:79], v21 offset:28672
    v_mfma_f32_16x16x32_bf16 v[236:239], v[40:43], v[128:131], v[236:239]
    s_waitcnt lgkmcnt(8)
    ds_read_b128 v[80:83], v22 offset:20480
    v_mfma_f32_16x16x32_bf16 v[240:243], v[44:47], v[128:131], v[240:243]
    s_waitcnt lgkmcnt(8)
    ds_read_b128 v[84:87], v22 offset:22528
    v_mfma_f32_16x16x32_bf16 v[244:247], v[48:51], v[128:131], v[244:247]
    s_waitcnt lgkmcnt(8)
    ds_read_b128 v[88:91], v22 offset:24576
    v_mfma_f32_16x16x32_bf16 v[248:251], v[52:55], v[128:131], v[248:251]
    s_waitcnt lgkmcnt(8)
    ds_read_b128 v[92:95], v22 offset:26624
    v_mfma_f32_16x16x32_bf16 v[252:255], v[56:59], v[128:131], v[252:255]
    s_waitcnt vmcnt(6) lgkmcnt(8)
    ds_read_b128 v[96:99], v22 offset:28672
    v_mfma_f32_16x16x32_bf16 v[236:239], v[60:63], v[132:135], v[236:239]
    s_waitcnt lgkmcnt(8)
    ds_read_b128 v[40:43], v21 offset:30720
    v_mfma_f32_16x16x32_bf16 v[240:243], v[64:67], v[132:135], v[240:243]
    s_waitcnt lgkmcnt(8)
    ds_read_b128 v[44:47], v21 offset:32768
    v_mfma_f32_16x16x32_bf16 v[244:247], v[68:71], v[132:135], v[244:247]
    s_waitcnt lgkmcnt(8)
    ds_read_b128 v[48:51], v21 offset:34816
    v_mfma_f32_16x16x32_bf16 v[248:251], v[72:75], v[132:135], v[248:251]
    s_waitcnt lgkmcnt(8)
    ds_read_b128 v[52:55], v21 offset:36864
    v_mfma_f32_16x16x32_bf16 v[252:255], v[76:79], v[132:135], v[252:255]
    s_waitcnt vmcnt(5) lgkmcnt(8)
    ds_read_b128 v[56:59], v21 offset:38912
    v_mfma_f32_16x16x32_bf16 v[236:239], v[80:83], v[136:139], v[236:239]
    s_waitcnt lgkmcnt(8)
    ds_read_b128 v[60:63], v22 offset:30720
    v_mfma_f32_16x16x32_bf16 v[240:243], v[84:87], v[136:139], v[240:243]
    s_waitcnt lgkmcnt(8)
    ds_read_b128 v[64:67], v22 offset:32768
    v_mfma_f32_16x16x32_bf16 v[244:247], v[88:91], v[136:139], v[244:247]
    s_waitcnt lgkmcnt(8)
    ds_read_b128 v[68:71], v22 offset:34816
    v_mfma_f32_16x16x32_bf16 v[248:251], v[92:95], v[136:139], v[248:251]
    s_waitcnt lgkmcnt(8)
    ds_read_b128 v[72:75], v22 offset:36864
    v_mfma_f32_16x16x32_bf16 v[252:255], v[96:99], v[136:139], v[252:255]
    s_waitcnt vmcnt(4) lgkmcnt(8)
    ds_read_b128 v[76:79], v22 offset:38912
    v_mfma_f32_16x16x32_bf16 v[236:239], v[40:43], v[140:143], v[236:239]
    s_waitcnt lgkmcnt(8)
    v_mfma_f32_16x16x32_bf16 v[240:243], v[44:47], v[140:143], v[240:243]
    s_waitcnt lgkmcnt(7)
    v_mfma_f32_16x16x32_bf16 v[244:247], v[48:51], v[140:143], v[244:247]
    s_waitcnt lgkmcnt(6)
    v_mfma_f32_16x16x32_bf16 v[248:251], v[52:55], v[140:143], v[248:251]
    s_waitcnt lgkmcnt(5)
    v_mfma_f32_16x16x32_bf16 v[252:255], v[56:59], v[140:143], v[252:255]
    s_waitcnt vmcnt(3) lgkmcnt(4)
    v_mfma_f32_16x16x32_bf16 v[236:239], v[60:63], v[144:147], v[236:239]
    s_waitcnt lgkmcnt(3)
    v_mfma_f32_16x16x32_bf16 v[240:243], v[64:67], v[144:147], v[240:243]
    s_waitcnt lgkmcnt(2)
    v_mfma_f32_16x16x32_bf16 v[244:247], v[68:71], v[144:147], v[244:247]
    s_waitcnt lgkmcnt(1)
    v_mfma_f32_16x16x32_bf16 v[248:251], v[72:75], v[144:147], v[248:251]
    s_waitcnt lgkmcnt(0)
    v_mfma_f32_16x16x32_bf16 v[252:255], v[76:79], v[144:147], v[252:255]
    s_mov_b32 s39, 0
    s_branch L_rxc
L_rx:
    buffer_load_dwordx4 v[216:219], v15, s[56:59], s61 offen offset:0 sc1
    buffer_load_dwordx4 v[220:223], v15, s[56:59], s61 offen offset:1024 sc1
    buffer_load_dwordx4 v[224:227], v15, s[56:59], s61 offen offset:2048 sc1
L_rxc:
    s_waitcnt vmcnt(0)
    v_xor_b32 v41, s51, v219
    v_xor_b32 v42, s51, v223
    v_or_b32 v41, v41, v42
    v_xor_b32_e64 v42, s51, v227
    v_lshl_or_b32 v40, v41, 16, v42
    v_cmp_ne_u32 vcc, 0, v40
    s_cbranch_vccz L_rxd
    s_add_u32 s39, s39, 1
    s_cmp_lt_u32 s39, 0x40000
    s_cbranch_scc0 L_rxd
    s_sleep 2
    s_branch L_rx
L_rxd:
    v_lshlrev_b32 v40, 16, v216
    v_and_b32 v41, s63, v216
    v_pk_add_f32 v[236:237], v[236:237], v[40:41]
    v_lshlrev_b32 v40, 16, v217
    v_and_b32 v41, s63, v217
    v_pk_add_f32 v[238:239], v[238:239], v[40:41]
    ds_write_b128 v24, v[236:239] offset:20480
    v_lshlrev_b32 v40, 16, v218
    v_and_b32 v41, s63, v218
    v_pk_add_f32 v[240:241], v[240:241], v[40:41]
    v_lshlrev_b32 v40, 16, v220
    v_and_b32 v41, s63, v220
    v_pk_add_f32 v[242:243], v[242:243], v[40:41]
    ds_write_b128 v25, v[240:243] offset:21504
    v_lshlrev_b32 v40, 16, v221
    v_and_b32 v41, s63, v221
    v_pk_add_f32 v[244:245], v[244:245], v[40:41]
    v_lshlrev_b32 v40, 16, v222
    v_and_b32 v41, s63, v222
    v_pk_add_f32 v[246:247], v[246:247], v[40:41]
    ds_write_b128 v26, v[244:247] offset:22528
    v_lshlrev_b32 v40, 16, v224
    v_and_b32 v41, s63, v224
    v_pk_add_f32 v[248:249], v[248:249], v[40:41]
    v_lshlrev_b32 v40, 16, v225
    v_and_b32 v41, s63, v225
    v_pk_add_f32 v[250:251], v[250:251], v[40:41]
    ds_write_b128 v27, v[248:251] offset:23552
    v_lshlrev_b32 v40, 16, v226
    v_and_b32 v41, s63, v226
    v_pk_add_f32 v[252:253], v[252:253], v[40:41]
    v_and_b32 v40, s63, v219
    v_and_b32 v41, s63, v223
    v_pk_add_f32 v[254:255], v[254:255], v[40:41]
    ds_write_b128 v24, v[252:255] offset:24576
    v_mov_b32_e64 v34, 8
    ds_write_b32 v32, v34 offset:3072
L_wk1:
    s_endpgm
L_slow_27:
    s_mov_b32 s39, 0
L_lw_39:
    ds_read_b32 v28, v33 offset:3072
    s_waitcnt lgkmcnt(0)
    v_cmp_gt_u32 vcc, 3, v28
    s_cbranch_vccz L_lw_39d
    s_add_u32 s39, s39, 1
    s_cmp_lt_u32 s39, 0x400000
    s_cbranch_scc0 L_lw_39d
    s_branch L_lw_39
L_lw_39d:
    s_branch L_back_28
L_slow_29:
    s_mov_b32 s39, 0
L_lw_40:
    ds_read_b32 v29, v33 offset:3120
    s_waitcnt lgkmcnt(0)
    v_cmp_gt_u32 vcc, 1, v29
    s_cbranch_vccz L_lw_40d
    s_add_u32 s39, s39, 1
    s_cmp_lt_u32 s39, 0x400000
    s_cbranch_scc0 L_lw_40d
    s_branch L_lw_40
L_lw_40d:
    s_branch L_back_30
L_slow_31:
    s_mov_b32 s39, 0
L_lw_41:
    ds_read_b32 v28, v33 offset:3136
    s_waitcnt lgkmcnt(0)
    v_cmp_gt_u32 vcc, 1, v28
    s_cbranch_vccz L_lw_41d
    s_add_u32 s39, s39, 1
    s_cmp_lt_u32 s39, 0x400000
    s_cbranch_scc0 L_lw_41d
    s_branch L_lw_41
L_lw_41d:
    s_branch L_back_32
L_slow_33:
    s_mov_b32 s39, 0
L_lw_42:
    ds_read_b32 v29, v33 offset:3136
    s_waitcnt lgkmcnt(0)
    v_cmp_gt_u32 vcc, 2, v29
    s_cbranch_vccz L_lw_42d
    s_add_u32 s39, s39, 1
    s_cmp_lt_u32 s39, 0x400000
    s_cbranch_scc0 L_lw_42d
    s_branch L_lw_42
L_lw_42d:
    s_branch L_back_34
L_slow_35:
    s_mov_b32 s39, 0
L_lw_43:
    ds_read_b32 v28, v33 offset:3072
    s_waitcnt lgkmcnt(0)
    v_cmp_gt_u32 vcc, 6, v28
    s_cbranch_vccz L_lw_43d
    s_add_u32 s39, s39, 1
    s_cmp_lt_u32 s39, 0x400000
    s_cbranch_scc0 L_lw_43d
    s_branch L_lw_43
L_lw_43d:
    s_branch L_back_36
L_slow_37:
    s_mov_b32 s39, 0
L_lw_44:
    ds_read_b32 v23, v32 offset:3152
    s_waitcnt lgkmcnt(0)
    v_cmp_gt_u32 vcc, 1, v23
    s_cbranch_vccz L_lw_44d
    s_add_u32 s39, s39, 1
    s_cmp_lt_u32 s39, 0x400000
    s_cbranch_scc0 L_lw_44d
    s_branch L_lw_44
L_lw_44d:
    s_branch L_back_38
L_compute:
    s_load_dword s51, s[40:41], 0x70000
    s_lshl1_add_u32 s50, s42, s53
    s_mul_i32 s5, s53, 10
    s_mul_i32 s6, s53, 14
    s_add_u32 s47, s6, s49
    s_add_u32 s5, s5, s49
    s_min_u32 s4, s49, 2
    s_add_u32 s45, s5, s4
    s_add_u32 s4, s45, 1
    s_add_u32 s5, s47, 6
    s_cmp_lt_u32 s49, 2
    s_cselect_b32 s44, 1, 0
    s_cselect_b32 s46, s4, s5
    s_min_u32 s48, s46, 26
    s_lshr_b32 s74, s52, 1
    s_and_b32 s75, s52, 1
    s_lshl_b32 s4, s45, 5
    s_lshl_b32 s5, s75, 4
    s_add_u32 s4, s4, s5
    v_add_u32 v17, s4, v1
    v_lshlrev_b32 v48, 1, v17
    s_lshl_b32 s4, s44, 6
    v_add_u32 v49, s4, v48
    v_mov_b32 v58, s10
    v_mov_b32_e64 v59, s11
    s_mov_b64 exec, 0xffff0000
    v_mov_b32 v58, s12
    v_mov_b32 v59, s13
    s_mov_b32 exec_lo, 0
    s_mov_b32 exec_hi, -1
    v_mov_b32 v58, s22
    v_mov_b32 v59, s23
    s_mov_b64 exec, -1
    v_add_co_u32 v60, vcc, v58, v48
    s_nop 1
    v_addc_co_u32 v61, vcc, 0, v59, vcc
    global_load_ushort v50, v[60:61], off
    v_add_co_u32 v60, vcc, v58, v49
    s_nop 1
    v_addc_co_u32 v61, vcc, 0, v59, vcc
    global_load_ushort v53, v[60:61], off
    s_mov_b32 s80, s40
    s_mov_b32 s81, s41
    s_mov_b32 s83, 0x20000
    s_cmp_eq_u32 s78, 0
    s_cselect_b32 s82, 0, 0xfe8000
    v_lshlrev_b32_e64 v77, 3, v77
    s_mov_b32 s56, s40
    s_mov_b32 s57, s41
    s_mov_b32 s58, 0xfe8000
    s_mov_b32 s59, 0x20000
    v_lshrrev_b32 v58, 1, v1
    v_xor_b32 v58, v58, v2
    v_lshlrev_b32_e64 v58, 4, v58
    v_lshl_add_u32 v58, v1, 7, v58
    s_lshl_b32 s4, s74, 13
    v_add_u32 v3, s4, v58
    v_xor_b32 v4, 64, v3
    s_lshl_b32 s4, s75, 11
    v_add_u32 v5, s4, v58
    v_xor_b32 v6, 64, v5
    v_bfe_u32 v59, v0, 2, 2
    v_lshl_add_u32 v60, v2, 3, v59
    v_lshlrev_b32_e64 v60, 7, v60
    v_bfe_u32 v61, v0, 3, 2
    s_lshl_b32 s4, s75, 1
    v_xor_b32 v61, s4, v61
    v_lshl_add_u32 v60, v61, 5, v60
    v_and_b32_e64 v61, 3, v0
    v_lshl_add_u32 v7, v61, 3, v60
    v_xor_b32 v8, 32, v7
    s_lshl_b32 s4, s74, 9
    s_add_u32 s4, s4, 81920
    v_lshl_add_u32 v9, v1, 3, s4
    s_lshl_b32 s4, s75, 8
    s_add_u32 s4, s4, 81920
    v_lshl_add_u32 v10, v1, 3, s4
    s_lshl_b32 s4, s74, 8
    s_add_u32 s4, s4, 81920
    v_lshl_add_u32 v11, v2, 6, s4
    v_lshlrev_b32 v12, 4, v0
    v_lshrrev_b32 v58, 5, v0
    v_lshlrev_b32 v58, 11, v58
    v_and_b32 v59, 31, v0
    v_lshl_add_u32 v58, v59, 4, v58
    s_lshl_b32 s4, s75, 9
    v_add_u32_e64 v13, s4, v58
    s_lshl_b32 s4, s52, 12
    s_add_u32 s4, s4, 86016
    v_lshl_add_u32 v58, v2, 2, v1
    v_and_b32_e64 v58, 15, v58
    v_lshl_add_u32 v58, v2, 4, v58
    v_lshl_add_u32 v14, v58, 4, s4
    v_and_b32_e64 v58, 1, v2
    v_bfe_u32 v59, v0, 2, 2
    v_lshl_add_u32 v58, v58, 3, v59
    v_and_b32_e64 v59, 3, v0
    v_lshl_add_u32 v58, v59, 2, v58
    v_add_u32 v58, 0, v58
    v_and_b32 v58, 15, v58
    v_lshl_add_u32 v58, v59, 4, v58
    v_lshrrev_b32_e64 v59, 5, v0
    v_lshl_add_u32 v58, v59, 7, v58
    v_lshl_add_u32 v15, v58, 4, s4
    v_and_b32_e64 v58, 1, v2
    v_bfe_u32 v59, v0, 2, 2
    v_lshl_add_u32 v58, v58, 3, v59
    v_and_b32_e64 v59, 3, v0
    v_lshl_add_u32 v58, v59, 2, v58
    v_add_u32 v58, 4, v58
    v_and_b32 v58, 15, v58
    v_lshl_add_u32 v58, v59, 4, v58
    v_lshrrev_b32_e64 v59, 5, v0
    v_lshl_add_u32 v58, v59, 7, v58
    v_lshl_add_u32 v16, v58, 4, s4
    s_mul_i32 s39, s50, 393216
    s_mul_i32 s4, s74, 196608
    s_add_u32 s39, s39, s4
    s_add_u32 s39, s39, 0xe8000
    s_mul_i32 s4, s42, 640
    v_add_u32 v17, s4, v17
    v_lshlrev_b32_e64 v17, 4, v17
    s_lshl3_add_u32 s4, s50, s49
    s_lshl_b32 s4, s4, 7
    s_add_u32 s4, s4, 0x58000
    v_lshl_add_u32 v18, v0, 2, s4
    s_mul_i32 s5, s53, 14
    s_sub_u32 s4, s46, s5
    s_lshl1_add_u32 s4, s4, s75
    s_lshl_b32 s4, s4, 10
    s_add_u32 s63, s4, s39
    s_mul_i32 s5, s53, 14
    s_sub_u32 s4, s47, s5
    s_lshl1_add_u32 s4, s4, s75
    s_lshl_b32 s4, s4, 10
    s_add_u32 s62, s4, s39
    v_mov_b32 v160, 0
    v_mov_b32 v161, 0
    v_mov_b32 v162, 0
    v_mov_b32 v163, 0
    v_mov_b32 v164, 0
    v_mov_b32 v165, 0
    v_mov_b32 v166, 0
    v_mov_b32 v167, 0
    v_mov_b32 v168, 0
    v_mov_b32 v169, 0
    v_mov_b32 v170, 0
    v_mov_b32 v171, 0
    v_mov_b32 v172, 0
    v_mov_b32 v173, 0
    v_mov_b32 v174, 0
    v_mov_b32 v175, 0
    v_mov_b32 v176, 0
    v_mov_b32 v177, 0
    v_mov_b32 v178, 0
    v_mov_b32 v179, 0
    v_mov_b32 v180, 0
    v_mov_b32 v181, 0
    v_mov_b32 v182, 0
    v_mov_b32 v183, 0
    v_mov_b32 v184, 0
    v_mov_b32 v185, 0
    v_mov_b32 v186, 0
    v_mov_b32 v187, 0
    v_mov_b32 v188, 0
    v_mov_b32 v189, 0
    v_mov_b32 v190, 0
    v_mov_b32 v191, 0
    v_mov_b32 v192, 0
    v_mov_b32 v193, 0
    v_mov_b32 v194, 0
    v_mov_b32 v195, 0
    v_mov_b32 v196, 0
    v_mov_b32 v197, 0
    v_mov_b32 v198, 0
    v_mov_b32 v199, 0
    v_mov_b32 v200, 0
    v_mov_b32 v201, 0
    v_mov_b32 v202, 0
    v_mov_b32 v203, 0
    v_mov_b32 v204, 0
    v_mov_b32 v205, 0
    v_mov_b32 v206, 0
    v_mov_b32 v207, 0
    v_mov_b32 v208, 0
    v_mov_b32 v209, 0
    v_mov_b32 v210, 0
    v_mov_b32 v211, 0
    v_mov_b32 v212, 0
    v_mov_b32 v213, 0
    v_mov_b32 v214, 0
    v_mov_b32 v215, 0
    v_mov_b32 v216, 0
    v_mov_b32 v217, 0
    v_mov_b32 v218, 0
    v_mov_b32 v219, 0
    v_mov_b32 v220, 0
    v_mov_b32 v221, 0
    v_mov_b32 v222, 0
    v_mov_b32 v223, 0
    v_mov_b32 v224, 0
    v_mov_b32 v225, 0
    v_mov_b32 v226, 0
    v_mov_b32 v227, 0
    v_mov_b32 v228, 0
    v_mov_b32 v229, 0
    v_mov_b32 v230, 0
    v_mov_b32 v231, 0
    v_mov_b32 v232, 0
    v_mov_b32 v233, 0
    v_mov_b32 v234, 0
    v_mov_b32 v235, 0
    v_mov_b32 v236, 0
    v_mov_b32 v237, 0
    v_mov_b32 v238, 0
    v_mov_b32 v239, 0
    v_mov_b32 v240, 0
    v_mov_b32 v241, 0
    v_mov_b32 v242, 0
    v_mov_b32 v243, 0
    v_mov_b32 v244, 0
    v_mov_b32 v245, 0
    v_mov_b32 v246, 0
    v_mov_b32 v247, 0
    v_mov_b32 v248, 0
    v_mov_b32 v249, 0
    v_mov_b32 v250, 0
    v_mov_b32 v251, 0
    v_mov_b32 v252, 0
    v_mov_b32 v253, 0
    v_mov_b32 v254, 0
    v_mov_b32 v255, 0
    v_cvt_f32_u32 v67, v2
    s_waitcnt lgkmcnt(0)
    s_mul_i32 s51, s51, 0x9e3779b1
    s_add_u32 s51, s51, 0x7f4a7c15
    s_cmp_eq_u32 s52, 1
    s_cbranch_scc1 L_r1_45
    s_cmp_eq_u32 s52, 2
    s_cbranch_scc1 L_r2_46
    s_waitcnt vmcnt(6)
    v_lshlrev_b32 v120, 16, v80
    v_and_b32 v121, 0xffff0000, v80
    v_lshlrev_b32_e64 v122, 16, v81
    v_and_b32 v123, 0xffff0000, v81
    v_lshlrev_b32_e64 v124, 16, v82
    v_and_b32 v125, 0xffff0000, v82
    v_pk_add_f32 v[68:69], v[120:121], v[124:125]
    v_lshlrev_b32_e64 v126, 16, v83
    v_and_b32 v127, 0xffff0000, v83
    v_pk_add_f32 v[70:71], v[122:123], v[126:127]
    s_waitcnt vmcnt(5)
    v_lshlrev_b32 v128, 16, v84
    v_and_b32 v129, 0xffff0000, v84
    v_pk_add_f32 v[68:69], v[68:69], v[128:129]
    v_lshlrev_b32_e64 v130, 16, v85
    v_and_b32 v131, 0xffff0000, v85
    v_pk_add_f32 v[70:71], v[70:71], v[130:131]
    v_lshlrev_b32_e64 v132, 16, v86
    v_and_b32 v133, 0xffff0000, v86
    v_pk_add_f32 v[68:69], v[68:69], v[132:133]
    v_lshlrev_b32_e64 v134, 16, v87
    v_and_b32 v135, 0xffff0000, v87
    v_pk_add_f32 v[70:71], v[70:71], v[134:135]
    s_waitcnt vmcnt(4)
    v_lshlrev_b32 v136, 16, v88
    v_and_b32 v137, 0xffff0000, v88
    v_pk_add_f32 v[68:69], v[68:69], v[136:137]
    v_lshlrev_b32_e64 v138, 16, v89
    v_and_b32 v139, 0xffff0000, v89
    v_pk_add_f32 v[70:71], v[70:71], v[138:139]
    v_lshlrev_b32_e64 v140, 16, v90
    v_and_b32 v141, 0xffff0000, v90
    v_pk_add_f32 v[68:69], v[68:69], v[140:141]
    v_lshlrev_b32_e64 v142, 16, v91
    v_and_b32 v143, 0xffff0000, v91
    v_pk_add_f32 v[70:71], v[70:71], v[142:143]
    s_waitcnt vmcnt(3)
    v_lshlrev_b32 v144, 16, v92
    v_and_b32 v145, 0xffff0000, v92
    v_pk_add_f32 v[68:69], v[68:69], v[144:145]
    v_lshlrev_b32_e64 v146, 16, v93
    v_and_b32 v147, 0xffff0000, v93
    v_pk_add_f32 v[70:71], v[70:71], v[146:147]
    v_lshlrev_b32_e64 v148, 16, v94
    v_and_b32 v149, 0xffff0000, v94
    v_pk_add_f32 v[68:69], v[68:69], v[148:149]
    v_lshlrev_b32_e64 v150, 16, v95
    v_and_b32 v151, 0xffff0000, v95
    v_pk_add_f32 v[70:71], v[70:71], v[150:151]
    s_waitcnt vmcnt(2)
    v_lshlrev_b32 v152, 16, v96
    v_and_b32 v153, 0xffff0000, v96
    v_pk_add_f32 v[68:69], v[68:69], v[152:153]
    v_lshlrev_b32_e64 v154, 16, v97
    v_and_b32 v155, 0xffff0000, v97
    v_pk_add_f32 v[70:71], v[70:71], v[154:155]
    v_lshlrev_b32_e64 v156, 16, v98
    v_and_b32 v157, 0xffff0000, v98
    v_pk_add_f32 v[68:69], v[68:69], v[156:157]
    v_lshlrev_b32_e64 v158, 16, v99
    v_and_b32 v159, 0xffff0000, v99
    v_pk_add_f32 v[70:71], v[70:71], v[158:159]
    v_pk_add_f32 v[68:69], v[68:69], v[70:71]
    v_add_f32 v68, v68, v69
    s_nop 1
    v_add_f32_dpp v68, v68, v68 quad_perm:[1,0,3,2] row_mask:0xf bank_mask:0xf
    s_nop 1
    v_add_f32_dpp v68, v68, v68 quad_perm:[2,3,0,1] row_mask:0xf bank_mask:0xf
    s_nop 1
    v_add_f32_dpp v68, v68, v68 row_half_mirror row_mask:0xf bank_mask:0xf
    s_nop 1
    s_nop 0
    v_add_f32_dpp v68, v68, v68 row_mirror row_mask:0xf bank_mask:0xf
    v_mul_f32 v68, 0xbacccccd, v68
    v_pk_add_f32 v[120:121], v[120:121], v[68:69] op_sel_hi:[1,0]
    v_pk_mul_f32 v[70:71], v[120:121], v[120:121]
    v_pk_add_f32 v[122:123], v[122:123], v[68:69] op_sel_hi:[1,0]
    v_pk_fma_f32 v[70:71], v[122:123], v[122:123], v[70:71]
    v_pk_add_f32 v[124:125], v[124:125], v[68:69] op_sel_hi:[1,0]
    v_pk_fma_f32 v[70:71], v[124:125], v[124:125], v[70:71]
    v_pk_add_f32 v[126:127], v[126:127], v[68:69] op_sel_hi:[1,0]
    v_pk_fma_f32 v[70:71], v[126:127], v[126:127], v[70:71]
    v_pk_add_f32 v[128:129], v[128:129], v[68:69] op_sel_hi:[1,0]
    v_pk_fma_f32 v[70:71], v[128:129], v[128:129], v[70:71]
    v_pk_add_f32 v[130:131], v[130:131], v[68:69] op_sel_hi:[1,0]
    v_pk_fma_f32 v[70:71], v[130:131], v[130:131], v[70:71]
    v_pk_add_f32 v[132:133], v[132:133], v[68:69] op_sel_hi:[1,0]
    v_pk_fma_f32 v[70:71], v[132:133], v[132:133], v[70:71]
    v_pk_add_f32 v[134:135], v[134:135], v[68:69] op_sel_hi:[1,0]
    v_pk_fma_f32 v[70:71], v[134:135], v[134:135], v[70:71]
    v_pk_add_f32 v[136:137], v[136:137], v[68:69] op_sel_hi:[1,0]
    v_pk_fma_f32 v[70:71], v[136:137], v[136:137], v[70:71]
    v_pk_add_f32 v[138:139], v[138:139], v[68:69] op_sel_hi:[1,0]
    v_pk_fma_f32 v[70:71], v[138:139], v[138:139], v[70:71]
    v_pk_add_f32 v[140:141], v[140:141], v[68:69] op_sel_hi:[1,0]
    v_pk_fma_f32 v[70:71], v[140:141], v[140:141], v[70:71]
    v_pk_add_f32 v[142:143], v[142:143], v[68:69] op_sel_hi:[1,0]
    v_pk_fma_f32 v[70:71], v[142:143], v[142:143], v[70:71]
    v_pk_add_f32 v[144:145], v[144:145], v[68:69] op_sel_hi:[1,0]
    v_pk_fma_f32 v[70:71], v[144:145], v[144:145], v[70:71]
    v_pk_add_f32 v[146:147], v[146:147], v[68:69] op_sel_hi:[1,0]
    v_pk_fma_f32 v[70:71], v[146:147], v[146:147], v[70:71]
    v_pk_add_f32 v[148:149], v[148:149], v[68:69] op_sel_hi:[1,0]
    v_pk_fma_f32 v[70:71], v[148:149], v[148:149], v[70:71]
    v_pk_add_f32 v[150:151], v[150:151], v[68:69] op_sel_hi:[1,0]
    v_pk_fma_f32 v[70:71], v[150:151], v[150:151], v[70:71]
    v_pk_add_f32 v[152:153], v[152:153], v[68:69] op_sel_hi:[1,0]
    v_pk_fma_f32 v[70:71], v[152:153], v[152:153], v[70:71]
    v_pk_add_f32 v[154:155], v[154:155], v[68:69] op_sel_hi:[1,0]
    v_pk_fma_f32 v[70:71], v[154:155], v[154:155], v[70:71]
    v_pk_add_f32 v[156:157], v[156:157], v[68:69] op_sel_hi:[1,0]
    v_pk_fma_f32 v[70:71], v[156:157], v[156:157], v[70:71]
    v_pk_add_f32 v[158:159], v[158:159], v[68:69] op_sel_hi:[1,0]
    v_pk_fma_f32 v[70:71], v[158:159], v[158:159], v[70:71]
    v_add_f32 v70, v70, v71
    s_nop 1
    v_add_f32_dpp v70, v70, v70 quad_perm:[1,0,3,2] row_mask:0xf bank_mask:0xf
    s_nop 1
    v_add_f32_dpp v70, v70, v70 quad_perm:[2,3,0,1] row_mask:0xf bank_mask:0xf
    s_nop 1
    v_add_f32_dpp v70, v70, v70 row_half_mirror row_mask:0xf bank_mask:0xf
    s_nop 1
    v_add_f32_dpp v70, v70, v70 row_mirror row_mask:0xf bank_mask:0xf
    v_mul_f32 v70, 0x3acccccd, v70
    v_cvt_pk_bf16_f32 v70, v70, v70
    v_lshlrev_b32 v70, 16, v70
    v_add_f32 v70, 0x3727c5ac, v70
    v_cvt_pk_bf16_f32 v70, v70, v70
    v_lshlrev_b32 v70, 16, v70
    v_sqrt_f32_e64 v70, v70
    s_nop 0
    v_cvt_pk_bf16_f32 v68, v68, v70
    v_mov_b32_e64 v69, s51
    s_mov_b32 exec_lo, 0xf000f
    s_mov_b32 exec_hi, 0xf000f
    buffer_store_dwordx2 v[68:69], v77, s[80:83], s84 offen sc1
    s_mov_b64 exec, -1
    s_branch L_re_47
L_r1_45:
    s_waitcnt vmcnt(11)
    v_lshlrev_b32 v68, 16, v80
    v_and_b32 v69, 0xffff0000, v80
    v_lshlrev_b32_e64 v70, 16, v81
    v_and_b32 v71, 0xffff0000, v81
    v_lshlrev_b32_e64 v124, 16, v82
    v_and_b32 v125, 0xffff0000, v82
    v_pk_add_f32 v[68:69], v[68:69], v[124:125]
    v_lshlrev_b32_e64 v126, 16, v83
    v_and_b32 v127, 0xffff0000, v83
    v_pk_add_f32 v[70:71], v[70:71], v[126:127]
    s_waitcnt vmcnt(10)
    v_lshlrev_b32 v120, 16, v84
    v_and_b32 v121, 0xffff0000, v84
    v_pk_add_f32 v[68:69], v[68:69], v[120:121]
    v_lshlrev_b32_e64 v122, 16, v85
    v_and_b32 v123, 0xffff0000, v85
    v_pk_add_f32 v[70:71], v[70:71], v[122:123]
    v_lshlrev_b32_e64 v124, 16, v86
    v_and_b32 v125, 0xffff0000, v86
    v_pk_add_f32 v[68:69], v[68:69], v[124:125]
    v_lshlrev_b32_e64 v126, 16, v87
    v_and_b32 v127, 0xffff0000, v87
    v_pk_add_f32 v[70:71], v[70:71], v[126:127]
    s_waitcnt vmcnt(9)
    v_lshlrev_b32 v120, 16, v88
    v_and_b32 v121, 0xffff0000, v88
    v_pk_add_f32 v[68:69], v[68:69], v[120:121]
    v_lshlrev_b32_e64 v122, 16, v89
    v_and_b32 v123, 0xffff0000, v89
    v_pk_add_f32 v[70:71], v[70:71], v[122:123]
    v_lshlrev_b32_e64 v124, 16, v90
    v_and_b32 v125, 0xffff0000, v90
    v_pk_add_f32 v[68:69], v[68:69], v[124:125]
    v_lshlrev_b32_e64 v126, 16, v91
    v_and_b32 v127, 0xffff0000, v91
    v_pk_add_f32 v[70:71], v[70:71], v[126:127]
    s_waitcnt vmcnt(8)
    v_lshlrev_b32 v120, 16, v92
    v_and_b32 v121, 0xffff0000, v92
    v_pk_add_f32 v[68:69], v[68:69], v[120:121]
    v_lshlrev_b32_e64 v122, 16, v93
    v_and_b32 v123, 0xffff0000, v93
    v_pk_add_f32 v[70:71], v[70:71], v[122:123]
    v_lshlrev_b32_e64 v124, 16, v94
    v_and_b32 v125, 0xffff0000, v94
    v_pk_add_f32 v[68:69], v[68:69], v[124:125]
    v_lshlrev_b32_e64 v126, 16, v95
    v_and_b32 v127, 0xffff0000, v95
    v_pk_add_f32 v[70:71], v[70:71], v[126:127]
    s_waitcnt vmcnt(7)
    v_lshlrev_b32 v120, 16, v96
    v_and_b32 v121, 0xffff0000, v96
    v_pk_add_f32 v[68:69], v[68:69], v[120:121]
    v_lshlrev_b32_e64 v122, 16, v97
    v_and_b32 v123, 0xffff0000, v97
    v_pk_add_f32 v[70:71], v[70:71], v[122:123]
    v_lshlrev_b32_e64 v124, 16, v98
    v_and_b32 v125, 0xffff0000, v98
    v_pk_add_f32 v[68:69], v[68:69], v[124:125]
    v_lshlrev_b32_e64 v126, 16, v99
    v_and_b32 v127, 0xffff0000, v99
    v_pk_add_f32 v[70:71], v[70:71], v[126:127]
    s_waitcnt vmcnt(6)
    v_lshlrev_b32 v120, 16, v100
    v_and_b32 v121, 0xffff0000, v100
    v_pk_add_f32 v[68:69], v[68:69], v[120:121]
    v_lshlrev_b32_e64 v122, 16, v101
    v_and_b32 v123, 0xffff0000, v101
    v_pk_add_f32 v[70:71], v[70:71], v[122:123]
    v_lshlrev_b32_e64 v124, 16, v102
    v_and_b32 v125, 0xffff0000, v102
    v_pk_add_f32 v[68:69], v[68:69], v[124:125]
    v_lshlrev_b32_e64 v126, 16, v103
    v_and_b32 v127, 0xffff0000, v103
    v_pk_add_f32 v[70:71], v[70:71], v[126:127]
    s_waitcnt vmcnt(5)
    v_lshlrev_b32 v120, 16, v104
    v_and_b32 v121, 0xffff0000, v104
    v_pk_add_f32 v[68:69], v[68:69], v[120:121]
    v_lshlrev_b32_e64 v122, 16, v105
    v_and_b32 v123, 0xffff0000, v105
    v_pk_add_f32 v[70:71], v[70:71], v[122:123]
    v_lshlrev_b32_e64 v124, 16, v106
    v_and_b32 v125, 0xffff0000, v106
    v_pk_add_f32 v[68:69], v[68:69], v[124:125]
    v_lshlrev_b32_e64 v126, 16, v107
    v_and_b32 v127, 0xffff0000, v107
    v_pk_add_f32 v[70:71], v[70:71], v[126:127]
    s_waitcnt vmcnt(4)
    v_lshlrev_b32 v120, 16, v108
    v_and_b32 v121, 0xffff0000, v108
    v_pk_add_f32 v[68:69], v[68:69], v[120:121]
    v_lshlrev_b32_e64 v122, 16, v109
    v_and_b32 v123, 0xffff0000, v109
    v_pk_add_f32 v[70:71], v[70:71], v[122:123]
    v_lshlrev_b32_e64 v124, 16, v110
    v_and_b32 v125, 0xffff0000, v110
    v_pk_add_f32 v[68:69], v[68:69], v[124:125]
    v_lshlrev_b32_e64 v126, 16, v111
    v_and_b32 v127, 0xffff0000, v111
    v_pk_add_f32 v[70:71], v[70:71], v[126:127]
    s_waitcnt vmcnt(3)
    v_lshlrev_b32 v120, 16, v112
    v_and_b32 v121, 0xffff0000, v112
    v_pk_add_f32 v[68:69], v[68:69], v[120:121]
    v_lshlrev_b32_e64 v122, 16, v113
    v_and_b32 v123, 0xffff0000, v113
    v_pk_add_f32 v[70:71], v[70:71], v[122:123]
    v_lshlrev_b32_e64 v124, 16, v114
    v_and_b32 v125, 0xffff0000, v114
    v_pk_add_f32 v[68:69], v[68:69], v[124:125]
    v_lshlrev_b32_e64 v126, 16, v115
    v_and_b32 v127, 0xffff0000, v115
    v_pk_add_f32 v[70:71], v[70:71], v[126:127]
    s_waitcnt vmcnt(2)
    v_lshlrev_b32 v120, 16, v116
    v_and_b32 v121, 0xffff0000, v116
    v_pk_add_f32 v[68:69], v[68:69], v[120:121]
    v_lshlrev_b32_e64 v122, 16, v117
    v_and_b32 v123, 0xffff0000, v117
    v_pk_add_f32 v[70:71], v[70:71], v[122:123]
    v_lshlrev_b32_e64 v124, 16, v118
    v_and_b32 v125, 0xffff0000, v118
    v_pk_add_f32 v[68:69], v[68:69], v[124:125]
    v_lshlrev_b32_e64 v126, 16, v119
    v_and_b32 v127, 0xffff0000, v119
    v_pk_add_f32 v[70:71], v[70:71], v[126:127]
    v_pk_add_f32 v[68:69], v[68:69], v[70:71]
    v_add_f32 v68, v68, v69
    s_nop 1
    v_add_f32_dpp v68, v68, v68 quad_perm:[1,0,3,2] row_mask:0xf bank_mask:0xf
    s_nop 1
    v_add_f32_dpp v68, v68, v68 quad_perm:[2,3,0,1] row_mask:0xf bank_mask:0xf
    s_nop 1
    v_add_f32_dpp v68, v68, v68 row_half_mirror row_mask:0xf bank_mask:0xf
    v_mov_b32_e64 v69, s51
    s_mov_b32 exec_lo, 0x3030303
    s_mov_b32 exec_hi, 0x3030303
    buffer_store_dwordx2 v[68:69], v77, s[80:83], s84 offen sc1
    s_mov_b64 exec, -1
    s_branch L_re_47
L_r2_46:
    s_waitcnt vmcnt(11)
    v_lshlrev_b32 v68, 16, v80
    v_and_b32 v69, 0xffff0000, v80
    v_lshlrev_b32_e64 v70, 16, v81
    v_and_b32 v71, 0xffff0000, v81
    v_lshlrev_b32_e64 v72, 16, v82
    v_and_b32 v73, 0xffff0000, v82
    v_lshlrev_b32_e64 v74, 16, v83
    v_and_b32 v75, 0xffff0000, v83
    s_waitcnt vmcnt(10)
    v_lshlrev_b32 v120, 16, v84
    v_and_b32 v121, 0xffff0000, v84
    v_pk_add_f32 v[68:69], v[68:69], v[120:121]
    v_lshlrev_b32_e64 v122, 16, v85
    v_and_b32 v123, 0xffff0000, v85
    v_pk_add_f32 v[70:71], v[70:71], v[122:123]
    v_lshlrev_b32_e64 v124, 16, v86
    v_and_b32 v125, 0xffff0000, v86
    v_pk_add_f32 v[72:73], v[72:73], v[124:125]
    v_lshlrev_b32_e64 v126, 16, v87
    v_and_b32 v127, 0xffff0000, v87
    v_pk_add_f32 v[74:75], v[74:75], v[126:127]
    s_waitcnt vmcnt(9)
    v_lshlrev_b32 v120, 16, v88
    v_and_b32 v121, 0xffff0000, v88
    v_pk_add_f32 v[68:69], v[68:69], v[120:121]
    v_lshlrev_b32_e64 v122, 16, v89
    v_and_b32 v123, 0xffff0000, v89
    v_pk_add_f32 v[70:71], v[70:71], v[122:123]
    v_lshlrev_b32_e64 v124, 16, v90
    v_and_b32 v125, 0xffff0000, v90
    v_pk_add_f32 v[72:73], v[72:73], v[124:125]
    v_lshlrev_b32_e64 v126, 16, v91
    v_and_b32 v127, 0xffff0000, v91
    v_pk_add_f32 v[74:75], v[74:75], v[126:127]
    s_waitcnt vmcnt(8)
    v_lshlrev_b32 v120, 16, v92
    v_and_b32 v121, 0xffff0000, v92
    v_pk_add_f32 v[68:69], v[68:69], v[120:121]
    v_lshlrev_b32_e64 v122, 16, v93
    v_and_b32 v123, 0xffff0000, v93
    v_pk_add_f32 v[70:71], v[70:71], v[122:123]
    v_lshlrev_b32_e64 v124, 16, v94
    v_and_b32 v125, 0xffff0000, v94
    v_pk_add_f32 v[72:73], v[72:73], v[124:125]
    v_lshlrev_b32_e64 v126, 16, v95
    v_and_b32 v127, 0xffff0000, v95
    v_pk_add_f32 v[74:75], v[74:75], v[126:127]
    s_waitcnt vmcnt(7)
    v_lshlrev_b32 v120, 16, v96
    v_and_b32 v121, 0xffff0000, v96
    v_pk_add_f32 v[68:69], v[68:69], v[120:121]
    v_lshlrev_b32_e64 v122, 16, v97
    v_and_b32 v123, 0xffff0000, v97
    v_pk_add_f32 v[70:71], v[70:71], v[122:123]
    v_lshlrev_b32_e64 v124, 16, v98
    v_and_b32 v125, 0xffff0000, v98
    v_pk_add_f32 v[72:73], v[72:73], v[124:125]
    v_lshlrev_b32_e64 v126, 16, v99
    v_and_b32 v127, 0xffff0000, v99
    v_pk_add_f32 v[74:75], v[74:75], v[126:127]
    s_waitcnt vmcnt(6)
    v_lshlrev_b32 v120, 16, v100
    v_and_b32 v121, 0xffff0000, v100
    v_pk_add_f32 v[68:69], v[68:69], v[120:121]
    v_lshlrev_b32_e64 v122, 16, v101
    v_and_b32 v123, 0xffff0000, v101
    v_pk_add_f32 v[70:71], v[70:71], v[122:123]
    v_lshlrev_b32_e64 v124, 16, v102
    v_and_b32 v125, 0xffff0000, v102
    v_pk_add_f32 v[72:73], v[72:73], v[124:125]
    v_lshlrev_b32_e64 v126, 16, v103
    v_and_b32 v127, 0xffff0000, v103
    v_pk_add_f32 v[74:75], v[74:75], v[126:127]
    s_waitcnt vmcnt(5)
    v_lshlrev_b32 v120, 16, v104
    v_and_b32 v121, 0xffff0000, v104
    v_pk_add_f32 v[68:69], v[68:69], v[120:121]
    v_lshlrev_b32_e64 v122, 16, v105
    v_and_b32 v123, 0xffff0000, v105
    v_pk_add_f32 v[70:71], v[70:71], v[122:123]
    v_lshlrev_b32_e64 v124, 16, v106
    v_and_b32 v125, 0xffff0000, v106
    v_pk_add_f32 v[72:73], v[72:73], v[124:125]
    v_lshlrev_b32_e64 v126, 16, v107
    v_and_b32 v127, 0xffff0000, v107
    v_pk_add_f32 v[74:75], v[74:75], v[126:127]
    s_waitcnt vmcnt(4)
    v_lshlrev_b32 v120, 16, v108
    v_and_b32 v121, 0xffff0000, v108
    v_pk_add_f32 v[68:69], v[68:69], v[120:121]
    v_lshlrev_b32_e64 v122, 16, v109
    v_and_b32 v123, 0xffff0000, v109
    v_pk_add_f32 v[70:71], v[70:71], v[122:123]
    v_lshlrev_b32_e64 v124, 16, v110
    v_and_b32 v125, 0xffff0000, v110
    v_pk_add_f32 v[72:73], v[72:73], v[124:125]
    v_lshlrev_b32_e64 v126, 16, v111
    v_and_b32 v127, 0xffff0000, v111
    v_pk_add_f32 v[74:75], v[74:75], v[126:127]
    s_waitcnt vmcnt(3)
    v_lshlrev_b32 v120, 16, v112
    v_and_b32 v121, 0xffff0000, v112
    v_pk_add_f32 v[68:69], v[68:69], v[120:121]
    v_lshlrev_b32_e64 v122, 16, v113
    v_and_b32 v123, 0xffff0000, v113
    v_pk_add_f32 v[70:71], v[70:71], v[122:123]
    v_lshlrev_b32_e64 v124, 16, v114
    v_and_b32 v125, 0xffff0000, v114
    v_pk_add_f32 v[72:73], v[72:73], v[124:125]
    v_lshlrev_b32_e64 v126, 16, v115
    v_and_b32 v127, 0xffff0000, v115
    v_pk_add_f32 v[74:75], v[74:75], v[126:127]
    s_waitcnt vmcnt(2)
    v_lshlrev_b32 v120, 16, v116
    v_and_b32 v121, 0xffff0000, v116
    v_pk_add_f32 v[68:69], v[68:69], v[120:121]
    v_lshlrev_b32_e64 v122, 16, v117
    v_and_b32 v123, 0xffff0000, v117
    v_pk_add_f32 v[70:71], v[70:71], v[122:123]
    v_lshlrev_b32_e64 v124, 16, v118
    v_and_b32 v125, 0xffff0000, v118
    v_pk_add_f32 v[72:73], v[72:73], v[124:125]
    v_lshlrev_b32_e64 v126, 16, v119
    v_and_b32 v127, 0xffff0000, v119
    v_pk_add_f32 v[74:75], v[74:75], v[126:127]
    v_permlane32_swap_b32 v68, v72
    v_permlane32_swap_b32 v69, v73
    v_permlane32_swap_b32 v70, v74
    v_permlane32_swap_b32 v71, v75
    v_add_f32 v68, v68, v72
    v_add_f32 v69, v69, v73
    v_add_f32 v70, v70, v74
    v_add_f32 v71, v71, v75
    s_nop 0
    v_permlane16_swap_b32 v68, v70
    v_permlane16_swap_b32 v69, v71
    v_add_f32 v68, v68, v70
    v_add_f32 v69, v69, v71
    s_nop 0
    v_add_f32_dpp v68, v68, v68 row_ror:8 row_mask:0xf bank_mask:0xf
    v_add_f32_dpp v69, v69, v69 row_ror:8 row_mask:0xf bank_mask:0xf
    s_mov_b32 vcc_lo, 0xff00ff00
    s_mov_b32 vcc_hi, 0xff00ff00
    v_cndmask_b32 v68, v68, v69, vcc
    v_mov_b32 v69, s51
    s_mov_b32 exec_lo, 0xffffffff
    s_mov_b32 exec_hi, 0xffffffff
    buffer_store_dwordx2 v[68:69], v77, s[80:83], s84 offen sc1
    s_mov_b64 exec, -1
L_re_47:
    s_waitcnt vmcnt(1)
    v_lshlrev_b32 v50, 16, v50
    v_mov_b32 v51, v50
    s_nop 1
    v_permlane16_swap_b32 v50, v51
    v_mov_b32 v52, v50
    v_mov_b32_e64 v58, v51
    s_nop 0
    v_permlane32_swap_b32 v50, v52
    v_permlane32_swap_b32 v51, v58
    v_mul_f32 v52, 0x3fb8aa3b, v52
    v_exp_f32 v52, v52
    s_nop 0
    v_cvt_pk_bf16_f32 v52, v52, v52
    v_lshlrev_b32 v52, 16, v52
    v_mul_f32 v58, v52, v50
    v_mul_f32_e64 v59, v52, v51
    v_mul_f32 v58, 0x3fb8aa3b, v58
    v_mul_f32 v59, 0.15915494, v59
    v_mov_b32 v60, v58
    v_mov_b32 v61, v59
    v_rndne_f32 v62, v61
    v_exp_f32 v60, v60
    v_sub_f32 v61, v61, v62
    v_cos_f32 v62, v61
    v_sin_f32 v63, v61
    v_mul_f32_e64 v20, v60, v62
    v_mul_f32_e64 v21, -v60, v63
    v_mul_f32 v60, 0x41800000, v58
    v_mul_f32 v61, 0x41800000, v59
    v_rndne_f32 v62, v61
    v_exp_f32 v60, v60
    v_sub_f32 v61, v61, v62
    v_cos_f32 v62, v61
    v_sin_f32 v63, v61
    v_mul_f32 v22, v60, v62
    v_mul_f32_e64 v23, -v60, v63
    v_mul_f32 v60, 0x42800000, v58
    v_mul_f32 v61, 0x42800000, v59
    v_rndne_f32 v62, v61
    v_exp_f32 v60, v60
    v_sub_f32 v61, v61, v62
    v_cos_f32 v62, v61
    v_sin_f32 v63, v61
    v_mul_f32 v24, v60, v62
    v_mul_f32_e64 v25, -v60, v63
    v_mul_f32 v60, 0x43000000, v58
    v_mul_f32 v61, 0x43000000, v59
    v_rndne_f32 v62, v61
    v_exp_f32 v60, v60
    v_sub_f32 v61, v61, v62
    v_cos_f32 v62, v61
    v_sin_f32 v63, v61
    v_mul_f32 v26, v60, v62
    v_mul_f32_e64 v27, -v60, v63
    v_mul_f32 v60, 0x41800000, v58
    v_mul_f32 v61, 0x41800000, v59
    v_mul_f32 v60, v60, v67
    v_mul_f32 v61, v61, v67
    v_rndne_f32 v62, v61
    v_exp_f32 v60, v60
    v_sub_f32 v61, v61, v62
    v_cos_f32 v62, v61
    v_sin_f32 v63, v61
    v_mul_f32 v28, v60, v62
    v_mul_f32_e64 v29, -v60, v63
    v_mul_f32 v60, 0x44000000, v58
    v_mul_f32 v61, 0x44000000, v59
    v_mul_f32 v60, v60, v67
    v_mul_f32 v61, v61, v67
    v_rndne_f32 v62, v61
    v_exp_f32 v60, v60
    v_sub_f32 v61, v61, v62
    v_cos_f32 v62, v61
    v_sin_f32 v63, v61
    v_mul_f32 v30, v60, v62
    v_mul_f32_e64 v31, -v60, v63
    v_add_f32 v58, -1.0, v20
    v_mul_f32 v59, v50, v50
    v_fmac_f32 v59, v51, v51
    v_rcp_f32 v59, v59
    v_mul_f32_e64 v60, v58, v50
    v_fma_f32 v60, -v21, v51, v60
    v_mul_f32_e64 v61, v21, v50
    v_fma_f32 v61, v58, v51, v61
    v_add_f32 v59, v59, v59
    v_mul_f32 v32, v60, v59
    v_mul_f32 v33, v61, v59
    s_cmp_eq_u32 s44, 0
    s_cbranch_scc1 L_par1
    v_lshlrev_b32 v53, 16, v53
    v_mov_b32 v54, v53
    s_nop 1
    v_permlane16_swap_b32 v53, v54
    v_mov_b32 v55, v53
    v_mov_b32 v58, v54
    s_nop 0
    v_permlane32_swap_b32 v53, v55
    v_permlane32_swap_b32 v54, v58
    v_mul_f32 v55, 0x3fb8aa3b, v55
    v_exp_f32 v55, v55
    s_nop 0
    v_cvt_pk_bf16_f32 v55, v55, v55
    v_lshlrev_b32 v55, 16, v55
    v_mul_f32 v58, v55, v53
    v_mul_f32_e64 v59, v55, v54
    v_mul_f32 v58, 0x3fb8aa3b, v58
    v_mul_f32 v59, 0.15915494, v59
    v_mov_b32 v60, v58
    v_mov_b32 v61, v59
    v_rndne_f32 v62, v61
    v_exp_f32 v60, v60
    v_sub_f32 v61, v61, v62
    v_cos_f32 v62, v61
    v_sin_f32 v63, v61
    v_mul_f32_e64 v34, v60, v62
    v_mul_f32_e64 v35, -v60, v63
    v_mul_f32 v60, 0x41800000, v58
    v_mul_f32 v61, 0x41800000, v59
    v_rndne_f32 v62, v61
    v_exp_f32 v60, v60
    v_sub_f32 v61, v61, v62
    v_cos_f32 v62, v61
    v_sin_f32 v63, v61
    v_mul_f32 v36, v60, v62
    v_mul_f32_e64 v37, -v60, v63
    v_mul_f32 v60, 0x42800000, v58
    v_mul_f32 v61, 0x42800000, v59
    v_rndne_f32 v62, v61
    v_exp_f32 v60, v60
    v_sub_f32 v61, v61, v62
    v_cos_f32 v62, v61
    v_sin_f32 v63, v61
    v_mul_f32 v38, v60, v62
    v_mul_f32_e64 v39, -v60, v63
    v_mul_f32 v60, 0x43000000, v58
    v_mul_f32 v61, 0x43000000, v59
    v_rndne_f32 v62, v61
    v_exp_f32 v60, v60
    v_sub_f32 v61, v61, v62
    v_cos_f32 v62, v61
    v_sin_f32 v63, v61
    v_mul_f32 v40, v60, v62
    v_mul_f32_e64 v41, -v60, v63
    v_mul_f32 v60, 0x41800000, v58
    v_mul_f32 v61, 0x41800000, v59
    v_mul_f32 v60, v60, v67
    v_mul_f32 v61, v61, v67
    v_rndne_f32 v62, v61
    v_exp_f32 v60, v60
    v_sub_f32 v61, v61, v62
    v_cos_f32 v62, v61
    v_sin_f32 v63, v61
    v_mul_f32 v42, v60, v62
    v_mul_f32_e64 v43, -v60, v63
    v_mul_f32 v60, 0x44000000, v58
    v_mul_f32 v61, 0x44000000, v59
    v_mul_f32 v60, v60, v67
    v_mul_f32 v61, v61, v67
    v_rndne_f32 v62, v61
    v_exp_f32 v60, v60
    v_sub_f32 v61, v61, v62
    v_cos_f32 v62, v61
    v_sin_f32 v63, v61
    v_mul_f32 v44, v60, v62
    v_mul_f32_e64 v45, -v60, v63
    v_add_f32 v58, -1.0, v34
    v_mul_f32 v59, v53, v53
    v_fmac_f32 v59, v54, v54
    v_rcp_f32 v59, v59
    v_mul_f32_e64 v60, v58, v53
    v_fma_f32 v60, -v35, v54, v60
    v_mul_f32_e64 v61, v35, v53
    v_fma_f32 v61, v58, v54, v61
    v_add_f32 v59, v59, v59
    v_mul_f32 v46, v60, v59
    v_mul_f32 v47, v61, v59
L_par1:
    v_mov_b32 v19, s51
    s_setprio 1
    s_mov_b32 s38, 0
    s_mov_b32 s6, -122880
    s_mov_b32 s7, 40960
    s_cmp_eq_u32 s44, 1
    s_cbranch_scc1 L_typeB
    s_barrier
    ds_read_b128 v[80:83], v3 offset:0
    ds_read_b128 v[84:87], v3 offset:2048
    ds_read_b128 v[88:91], v3 offset:4096
    ds_read_b128 v[92:95], v3 offset:6144
    ds_read_b128 v[96:99], v5 offset:16384
    ds_read_b128 v[100:103], v5 offset:20480
    ds_read_b64_tr_b16 v[104:105], v7 offset:24576
    ds_read_b64_tr_b16 v[106:107], v7 offset:25088
    ds_read_b64_tr_b16 v[108:109], v8 offset:24576
    ds_read_b64_tr_b16 v[110:111], v8 offset:25088
    ds_read_b64_tr_b16 v[112:113], v7 offset:32768
    ds_read_b64_tr_b16 v[114:115], v7 offset:33280
    ds_read_b64_tr_b16 v[116:117], v8 offset:32768
    ds_read_b64_tr_b16 v[118:119], v8 offset:33280
    s_branch L_midA
.p2align 4
L_topA:
    s_waitcnt lgkmcnt(0)
    s_barrier
    v_mfma_f32_16x16x32_bf16 v[160:163], v[120:123], v[136:139], v[160:163]
    ds_read_b128 v[80:83], v3 offset:0
    v_mfma_f32_16x16x32_bf16 v[164:167], v[124:127], v[136:139], v[164:167]
    ds_read_b128 v[84:87], v3 offset:2048
    v_mfma_f32_16x16x32_bf16 v[168:171], v[128:131], v[136:139], v[168:171]
    ds_read_b128 v[88:91], v3 offset:4096
    v_mfma_f32_16x16x32_bf16 v[172:175], v[132:135], v[136:139], v[172:175]
    ds_read_b128 v[92:95], v3 offset:6144
    v_mfma_f32_16x16x32_bf16 v[188:191], v[132:135], v[140:143], v[188:191]
    ds_read_b128 v[96:99], v5 offset:16384
    v_mfma_f32_16x16x32_bf16 v[184:187], v[128:131], v[140:143], v[184:187]
    ds_read_b128 v[100:103], v5 offset:20480
    v_mfma_f32_16x16x32_bf16 v[180:183], v[124:127], v[140:143], v[180:183]
    ds_read_b64_tr_b16 v[104:105], v7 offset:24576
    v_mfma_f32_16x16x32_bf16 v[176:179], v[120:123], v[140:143], v[176:179]
    ds_read_b64_tr_b16 v[106:107], v7 offset:25088
    v_mfma_f32_16x16x32_bf16 v[192:195], v[144:147], v[120:123], v[192:195]
    ds_read_b64_tr_b16 v[108:109], v8 offset:24576
    v_mfma_f32_16x16x32_bf16 v[196:199], v[144:147], v[124:127], v[196:199]
    ds_read_b64_tr_b16 v[110:111], v8 offset:25088
    v_mfma_f32_16x16x32_bf16 v[200:203], v[144:147], v[128:131], v[200:203]
    ds_read_b64_tr_b16 v[112:113], v7 offset:32768
    v_mfma_f32_16x16x32_bf16 v[204:207], v[144:147], v[132:135], v[204:207]
    ds_read_b64_tr_b16 v[114:115], v7 offset:33280
    v_mfma_f32_16x16x32_bf16 v[220:223], v[148:151], v[132:135], v[220:223]
    ds_read_b64_tr_b16 v[116:117], v8 offset:32768
    v_mfma_f32_16x16x32_bf16 v[216:219], v[148:151], v[128:131], v[216:219]
    ds_read_b64_tr_b16 v[118:119], v8 offset:33280
    v_mfma_f32_16x16x32_bf16 v[212:215], v[148:151], v[124:127], v[212:215]
    v_mfma_f32_16x16x32_bf16 v[208:211], v[148:151], v[120:123], v[208:211]
    v_mfma_f32_16x16x32_bf16 v[224:227], v[152:155], v[120:123], v[224:227]
    v_mfma_f32_16x16x32_bf16 v[228:231], v[152:155], v[124:127], v[228:231]
    v_mfma_f32_16x16x32_bf16 v[232:235], v[152:155], v[128:131], v[232:235]
    v_mfma_f32_16x16x32_bf16 v[236:239], v[152:155], v[132:135], v[236:239]
    v_mfma_f32_16x16x32_bf16 v[252:255], v[156:159], v[132:135], v[252:255]
    v_mfma_f32_16x16x32_bf16 v[248:251], v[156:159], v[128:131], v[248:251]
    v_mfma_f32_16x16x32_bf16 v[244:247], v[156:159], v[124:127], v[244:247]
    v_mfma_f32_16x16x32_bf16 v[240:243], v[156:159], v[120:123], v[240:243]
L_midA:
    s_waitcnt lgkmcnt(0)
    s_and_b32 s4, s38, 3
    v_mfma_f32_16x16x32_bf16 v[160:163], v[80:83], v[96:99], v[160:163]
    ds_read_b128 v[120:123], v4 offset:0
    v_mfma_f32_16x16x32_bf16 v[164:167], v[84:87], v[96:99], v[164:167]
    ds_read_b128 v[124:127], v4 offset:2048
    v_mfma_f32_16x16x32_bf16 v[168:171], v[88:91], v[96:99], v[168:171]
    ds_read_b128 v[128:131], v4 offset:4096
    v_mfma_f32_16x16x32_bf16 v[172:175], v[92:95], v[96:99], v[172:175]
    ds_read_b128 v[132:135], v4 offset:6144
    v_mfma_f32_16x16x32_bf16 v[188:191], v[92:95], v[100:103], v[188:191]
    ds_read_b128 v[136:139], v6 offset:16384
    v_mfma_f32_16x16x32_bf16 v[184:187], v[88:91], v[100:103], v[184:187]
    ds_read_b128 v[140:143], v6 offset:20480
    v_mfma_f32_16x16x32_bf16 v[180:183], v[84:87], v[100:103], v[180:183]
    ds_read_b64_tr_b16 v[144:145], v7 offset:28672
    v_mfma_f32_16x16x32_bf16 v[176:179], v[80:83], v[100:103], v[176:179]
    ds_read_b64_tr_b16 v[146:147], v7 offset:29184
    v_mfma_f32_16x16x32_bf16 v[192:195], v[104:107], v[80:83], v[192:195]
    ds_read_b64_tr_b16 v[148:149], v8 offset:28672
    v_mfma_f32_16x16x32_bf16 v[196:199], v[104:107], v[84:87], v[196:199]
    ds_read_b64_tr_b16 v[150:151], v8 offset:29184
    v_mfma_f32_16x16x32_bf16 v[200:203], v[104:107], v[88:91], v[200:203]
    ds_read_b64_tr_b16 v[152:153], v7 offset:36864
    v_mfma_f32_16x16x32_bf16 v[204:207], v[104:107], v[92:95], v[204:207]
    ds_read_b64_tr_b16 v[154:155], v7 offset:37376
    v_mfma_f32_16x16x32_bf16 v[220:223], v[108:111], v[92:95], v[220:223]
    ds_read_b64_tr_b16 v[156:157], v8 offset:36864
    v_mfma_f32_16x16x32_bf16 v[216:219], v[108:111], v[88:91], v[216:219]
    ds_read_b64_tr_b16 v[158:159], v8 offset:37376
    v_mfma_f32_16x16x32_bf16 v[212:215], v[108:111], v[84:87], v[212:215]
    s_cmp_eq_u32 s4, 3
    s_cselect_b32 s27, s6, s7
    v_add_u32_e64 v3, s27, v3
    v_mfma_f32_16x16x32_bf16 v[208:211], v[108:111], v[80:83], v[208:211]
    v_add_u32_e64 v4, s27, v4
    v_mfma_f32_16x16x32_bf16 v[224:227], v[112:115], v[80:83], v[224:227]
    v_add_u32_e64 v5, s27, v5
    v_mfma_f32_16x16x32_bf16 v[228:231], v[112:115], v[84:87], v[228:231]
    v_add_u32_e64 v6, s27, v6
    v_mfma_f32_16x16x32_bf16 v[232:235], v[112:115], v[88:91], v[232:235]
    v_add_u32_e64 v7, s27, v7
    v_mfma_f32_16x16x32_bf16 v[236:239], v[112:115], v[92:95], v[236:239]
    v_add_u32_e64 v8, s27, v8
    v_mfma_f32_16x16x32_bf16 v[252:255], v[116:119], v[92:95], v[252:255]
    s_add_u32 s38, s38, 1
    s_cmp_lt_u32 s38, 10
    v_mfma_f32_16x16x32_bf16 v[248:251], v[116:119], v[88:91], v[248:251]
    v_mfma_f32_16x16x32_bf16 v[244:247], v[116:119], v[84:87], v[244:247]
    v_mfma_f32_16x16x32_bf16 v[240:243], v[116:119], v[80:83], v[240:243]
    s_cbranch_scc1 L_topA
    s_waitcnt lgkmcnt(0)
    v_mfma_f32_16x16x32_bf16 v[160:163], v[120:123], v[136:139], v[160:163]
    v_mov_b32 v88, 0
    v_mov_b32 v89, 0
    v_mfma_f32_16x16x32_bf16 v[164:167], v[124:127], v[136:139], v[164:167]
    v_mov_b32 v90, 0
    v_mov_b32 v91, 0
    v_mfma_f32_16x16x32_bf16 v[168:171], v[128:131], v[136:139], v[168:171]
    v_mov_b32 v92, 0
    v_mov_b32 v93, 0
    v_mfma_f32_16x16x32_bf16 v[172:175], v[132:135], v[136:139], v[172:175]
    v_mov_b32 v94, 0
    v_mov_b32 v95, 0
    v_mfma_f32_16x16x32_bf16 v[188:191], v[132:135], v[140:143], v[188:191]
    v_mov_b32 v96, 0
    v_mov_b32 v97, 0
    v_mfma_f32_16x16x32_bf16 v[184:187], v[128:131], v[140:143], v[184:187]
    v_mov_b32 v98, 0
    v_mov_b32 v99, 0
    v_mfma_f32_16x16x32_bf16 v[180:183], v[124:127], v[140:143], v[180:183]
    s_mov_b64 exec, 0xffff
    ds_read_b64 v[88:89], v10 offset:1024
    s_mov_b64 exec, -1
    v_mfma_f32_16x16x32_bf16 v[176:179], v[120:123], v[140:143], v[176:179]
    s_mov_b64 exec, 0xffff
    ds_read_b64 v[90:91], v10 offset:1152
    s_mov_b64 exec, -1
    v_mfma_f32_16x16x32_bf16 v[192:195], v[144:147], v[120:123], v[192:195]
    s_mov_b64 exec, 0xffff
    ds_read_b64 v[92:93], v10 offset:1536
    s_mov_b64 exec, -1
    v_mfma_f32_16x16x32_bf16 v[196:199], v[144:147], v[124:127], v[196:199]
    s_mov_b64 exec, 0xffff
    ds_read_b64 v[94:95], v10 offset:1664
    s_mov_b64 exec, -1
    v_mfma_f32_16x16x32_bf16 v[200:203], v[144:147], v[128:131], v[200:203]
    s_mov_b64 exec, 0xffff
    ds_read_b64 v[96:97], v10 offset:2048
    s_mov_b64 exec, -1
    v_mfma_f32_16x16x32_bf16 v[204:207], v[144:147], v[132:135], v[204:207]
    s_mov_b64 exec, 0xffff
    ds_read_b64 v[98:99], v10 offset:2176
    s_mov_b64 exec, -1
    v_mfma_f32_16x16x32_bf16 v[220:223], v[148:151], v[132:135], v[220:223]
    ds_read_b64 v[80:81], v9 offset:0
    v_mfma_f32_16x16x32_bf16 v[216:219], v[148:151], v[128:131], v[216:219]
    ds_read_b64 v[82:83], v9 offset:128
    v_mfma_f32_16x16x32_bf16 v[212:215], v[148:151], v[124:127], v[212:215]
    ds_read_b64 v[84:85], v9 offset:256
    v_mfma_f32_16x16x32_bf16 v[208:211], v[148:151], v[120:123], v[208:211]
    ds_read_b64 v[86:87], v9 offset:384
    v_mfma_f32_16x16x32_bf16 v[224:227], v[152:155], v[120:123], v[224:227]
    ds_read_b128 v[100:103], v11 offset:2560
    v_mfma_f32_16x16x32_bf16 v[228:231], v[152:155], v[124:127], v[228:231]
    ds_read_b128 v[104:107], v11 offset:2576
    v_mfma_f32_16x16x32_bf16 v[232:235], v[152:155], v[128:131], v[232:235]
    ds_read_b128 v[108:111], v11 offset:2592
    v_mfma_f32_16x16x32_bf16 v[236:239], v[152:155], v[132:135], v[236:239]
    ds_read_b128 v[112:115], v11 offset:2608
    v_mfma_f32_16x16x32_bf16 v[252:255], v[156:159], v[132:135], v[252:255]
    v_mfma_f32_16x16x32_bf16 v[248:251], v[156:159], v[128:131], v[248:251]
    v_mfma_f32_16x16x32_bf16 v[244:247], v[156:159], v[124:127], v[244:247]
    v_mfma_f32_16x16x32_bf16 v[240:243], v[156:159], v[120:123], v[240:243]
    s_waitcnt lgkmcnt(0)
    v_mfma_f32_16x16x16_bf16 v[224:227], v[96:97], v[80:81], v[224:227]
    v_and_b32 v120, 0xffff0000, v81
    v_rcp_f32 v120, v120
    v_mfma_f32_16x16x16_bf16 v[240:243], v[98:99], v[80:81], v[240:243]
    v_and_b32 v121, 0xffff0000, v83
    v_rcp_f32_e64 v121, v121
    v_mfma_f32_16x16x16_bf16 v[228:231], v[96:97], v[82:83], v[228:231]
    v_and_b32 v122, 0xffff0000, v85
    v_rcp_f32_e64 v122, v122
    v_mfma_f32_16x16x16_bf16 v[244:247], v[98:99], v[82:83], v[244:247]
    v_and_b32 v123, 0xffff0000, v87
    v_rcp_f32_e64 v123, v123
    v_mfma_f32_16x16x16_bf16 v[232:235], v[96:97], v[84:85], v[232:235]
    v_max_f32 v224, 0, v224
    v_max_f32 v225, 0, v225
    v_mfma_f32_16x16x16_bf16 v[248:251], v[98:99], v[84:85], v[248:251]
    v_max_f32 v226, 0, v226
    v_max_f32 v227, 0, v227
    v_pk_mul_f32 v[224:225], v[120:121], v[224:225] op_sel:[0,0] op_sel_hi:[0,1]
    v_pk_mul_f32 v[226:227], v[120:121], v[226:227] op_sel:[0,0] op_sel_hi:[0,1]
    v_pk_mul_f32 v[224:225], v[224:225], v[224:225]
    v_pk_mul_f32 v[226:227], v[226:227], v[226:227]
    v_cvt_pk_bf16_f32 v132, v224, v225
    v_cvt_pk_bf16_f32 v133, v226, v227
    v_mfma_f32_16x16x16_bf16 v[236:239], v[96:97], v[86:87], v[236:239]
    v_max_f32 v240, 0, v240
    v_max_f32 v241, 0, v241
    v_mfma_f32_16x16x16_bf16 v[252:255], v[98:99], v[86:87], v[252:255]
    v_max_f32 v242, 0, v242
    v_max_f32 v243, 0, v243
    v_pk_mul_f32 v[240:241], v[120:121], v[240:241] op_sel:[0,0] op_sel_hi:[0,1]
    v_pk_mul_f32 v[242:243], v[120:121], v[242:243] op_sel:[0,0] op_sel_hi:[0,1]
    v_pk_mul_f32 v[240:241], v[240:241], v[240:241]
    v_pk_mul_f32 v[242:243], v[242:243], v[242:243]
    v_cvt_pk_bf16_f32 v134, v240, v241
    v_cvt_pk_bf16_f32 v135, v242, v243
    buffer_store_dwordx4 v[132:135], v12, s[56:59], s62 offen sc1
    s_add_u32 s62, s62, 49152
    v_mfma_f32_16x16x16_bf16 v[160:163], v[80:81], v[88:89], v[160:163]
    v_max_f32 v228, 0, v228
    v_max_f32 v229, 0, v229
    v_mfma_f32_16x16x16_bf16 v[176:179], v[80:81], v[90:91], v[176:179]
    v_max_f32 v230, 0, v230
    v_max_f32 v231, 0, v231
    v_pk_mul_f32 v[228:229], v[120:121], v[228:229] op_sel:[1,0] op_sel_hi:[1,1]
    v_pk_mul_f32 v[230:231], v[120:121], v[230:231] op_sel:[1,0] op_sel_hi:[1,1]
    v_pk_mul_f32 v[228:229], v[228:229], v[228:229]
    v_pk_mul_f32 v[230:231], v[230:231], v[230:231]
    v_cvt_pk_bf16_f32 v136, v228, v229
    v_cvt_pk_bf16_f32 v137, v230, v231
    v_mfma_f32_16x16x16_bf16 v[164:167], v[82:83], v[88:89], v[164:167]
    v_max_f32 v244, 0, v244
    v_max_f32 v245, 0, v245
    v_mfma_f32_16x16x16_bf16 v[180:183], v[82:83], v[90:91], v[180:183]
    v_max_f32 v246, 0, v246
    v_max_f32 v247, 0, v247
    v_pk_mul_f32 v[244:245], v[120:121], v[244:245] op_sel:[1,0] op_sel_hi:[1,1]
    v_pk_mul_f32 v[246:247], v[120:121], v[246:247] op_sel:[1,0] op_sel_hi:[1,1]
    v_pk_mul_f32 v[244:245], v[244:245], v[244:245]
    v_pk_mul_f32 v[246:247], v[246:247], v[246:247]
    v_cvt_pk_bf16_f32 v138, v244, v245
    v_cvt_pk_bf16_f32 v139, v246, v247
    buffer_store_dwordx4 v[136:139], v12, s[56:59], s62 offen sc1
    s_add_u32 s62, s62, 49152
    v_mfma_f32_16x16x16_bf16 v[168:171], v[84:85], v[88:89], v[168:171]
    v_max_f32 v232, 0, v232
    v_max_f32 v233, 0, v233
    v_mfma_f32_16x16x16_bf16 v[184:187], v[84:85], v[90:91], v[184:187]
    v_max_f32 v234, 0, v234
    v_max_f32 v235, 0, v235
    v_pk_mul_f32 v[232:233], v[122:123], v[232:233] op_sel:[0,0] op_sel_hi:[0,1]
    v_pk_mul_f32 v[234:235], v[122:123], v[234:235] op_sel:[0,0] op_sel_hi:[0,1]
    v_pk_mul_f32 v[232:233], v[232:233], v[232:233]
    v_pk_mul_f32 v[234:235], v[234:235], v[234:235]
    v_cvt_pk_bf16_f32 v140, v232, v233
    v_cvt_pk_bf16_f32 v141, v234, v235
    v_mfma_f32_16x16x16_bf16 v[172:175], v[86:87], v[88:89], v[172:175]
    v_max_f32 v248, 0, v248
    v_max_f32 v249, 0, v249
    v_mfma_f32_16x16x16_bf16 v[188:191], v[86:87], v[90:91], v[188:191]
    v_max_f32 v250, 0, v250
    v_max_f32 v251, 0, v251
    v_pk_mul_f32 v[248:249], v[122:123], v[248:249] op_sel:[0,0] op_sel_hi:[0,1]
    v_pk_mul_f32 v[250:251], v[122:123], v[250:251] op_sel:[0,0] op_sel_hi:[0,1]
    v_pk_mul_f32 v[248:249], v[248:249], v[248:249]
    v_pk_mul_f32 v[250:251], v[250:251], v[250:251]
    v_cvt_pk_bf16_f32 v142, v248, v249
    v_cvt_pk_bf16_f32 v143, v250, v251
    buffer_store_dwordx4 v[140:143], v12, s[56:59], s62 offen sc1
    s_add_u32 s62, s62, 49152
    v_mfma_f32_16x16x16_bf16 v[192:195], v[92:93], v[80:81], v[192:195]
    v_max_f32 v236, 0, v236
    v_max_f32 v237, 0, v237
    v_mfma_f32_16x16x16_bf16 v[208:211], v[94:95], v[80:81], v[208:211]
    v_max_f32 v238, 0, v238
    v_max_f32 v239, 0, v239
    v_pk_mul_f32 v[236:237], v[122:123], v[236:237] op_sel:[1,0] op_sel_hi:[1,1]
    v_pk_mul_f32 v[238:239], v[122:123], v[238:239] op_sel:[1,0] op_sel_hi:[1,1]
    v_pk_mul_f32 v[236:237], v[236:237], v[236:237]
    v_pk_mul_f32 v[238:239], v[238:239], v[238:239]
    v_cvt_pk_bf16_f32 v144, v236, v237
    v_cvt_pk_bf16_f32 v145, v238, v239
    v_mfma_f32_16x16x16_bf16 v[196:199], v[92:93], v[82:83], v[196:199]
    v_max_f32 v252, 0, v252
    v_max_f32 v253, 0, v253
    v_mfma_f32_16x16x16_bf16 v[212:215], v[94:95], v[82:83], v[212:215]
    v_max_f32 v254, 0, v254
    v_max_f32 v255, 0, v255
    v_pk_mul_f32 v[252:253], v[122:123], v[252:253] op_sel:[1,0] op_sel_hi:[1,1]
    v_pk_mul_f32 v[254:255], v[122:123], v[254:255] op_sel:[1,0] op_sel_hi:[1,1]
    v_pk_mul_f32 v[252:253], v[252:253], v[252:253]
    v_pk_mul_f32 v[254:255], v[254:255], v[254:255]
    v_cvt_pk_bf16_f32 v146, v252, v253
    v_cvt_pk_bf16_f32 v147, v254, v255
    buffer_store_dwordx4 v[144:147], v12, s[56:59], s62 offen sc1
    s_add_u32 s62, s62, 49152
    v_pk_mul_f32 v[52:53], v[160:161], v[32:33] op_sel:[0,0] op_sel_hi:[0,1]
    v_pk_fma_f32 v[52:53], v[32:33], v[176:177], v[52:53] op_sel:[1,0,0] op_sel_hi:[0,0,1] neg_hi:[1,0,0]
    v_pk_mul_f32 v[54:55], v[160:161], v[32:33] op_sel:[1,0] op_sel_hi:[1,1]
    v_pk_fma_f32 v[54:55], v[32:33], v[176:177], v[54:55] op_sel:[1,1,0] op_sel_hi:[0,1,1] neg_hi:[1,0,0]
    v_pk_mul_f32 v[160:161], v[52:53], v[100:101] op_sel_hi:[1,0]
    v_pk_mul_f32 v[176:177], v[100:101], v[54:55] op_sel:[1,0] op_sel_hi:[1,1]
    v_pk_mul_f32 v[52:53], v[162:163], v[32:33] op_sel:[0,0] op_sel_hi:[0,1]
    v_pk_fma_f32 v[52:53], v[32:33], v[178:179], v[52:53] op_sel:[1,0,0] op_sel_hi:[0,0,1] neg_hi:[1,0,0]
    v_pk_mul_f32 v[54:55], v[162:163], v[32:33] op_sel:[1,0] op_sel_hi:[1,1]
    v_pk_fma_f32 v[54:55], v[32:33], v[178:179], v[54:55] op_sel:[1,1,0] op_sel_hi:[0,1,1] neg_hi:[1,0,0]
    v_pk_mul_f32 v[162:163], v[52:53], v[102:103] op_sel_hi:[1,0]
    v_pk_mul_f32 v[178:179], v[102:103], v[54:55] op_sel:[1,0] op_sel_hi:[1,1]
    v_pk_mul_f32 v[52:53], v[164:165], v[32:33] op_sel:[0,0] op_sel_hi:[0,1]
    v_pk_fma_f32 v[52:53], v[32:33], v[180:181], v[52:53] op_sel:[1,0,0] op_sel_hi:[0,0,1] neg_hi:[1,0,0]
    v_pk_mul_f32 v[54:55], v[164:165], v[32:33] op_sel:[1,0] op_sel_hi:[1,1]
    v_pk_fma_f32 v[54:55], v[32:33], v[180:181], v[54:55] op_sel:[1,1,0] op_sel_hi:[0,1,1] neg_hi:[1,0,0]
    v_pk_mul_f32 v[164:165], v[52:53], v[104:105] op_sel_hi:[1,0]
    v_pk_mul_f32 v[180:181], v[104:105], v[54:55] op_sel:[1,0] op_sel_hi:[1,1]
    v_pk_mul_f32 v[52:53], v[166:167], v[32:33] op_sel:[0,0] op_sel_hi:[0,1]
    v_pk_fma_f32 v[52:53], v[32:33], v[182:183], v[52:53] op_sel:[1,0,0] op_sel_hi:[0,0,1] neg_hi:[1,0,0]
    v_pk_mul_f32 v[54:55], v[166:167], v[32:33] op_sel:[1,0] op_sel_hi:[1,1]
    v_pk_fma_f32 v[54:55], v[32:33], v[182:183], v[54:55] op_sel:[1,1,0] op_sel_hi:[0,1,1] neg_hi:[1,0,0]
    v_pk_mul_f32 v[166:167], v[52:53], v[106:107] op_sel_hi:[1,0]
    v_pk_mul_f32 v[182:183], v[106:107], v[54:55] op_sel:[1,0] op_sel_hi:[1,1]
    v_pk_mul_f32 v[52:53], v[168:169], v[32:33] op_sel:[0,0] op_sel_hi:[0,1]
    v_pk_fma_f32 v[52:53], v[32:33], v[184:185], v[52:53] op_sel:[1,0,0] op_sel_hi:[0,0,1] neg_hi:[1,0,0]
    v_pk_mul_f32 v[54:55], v[168:169], v[32:33] op_sel:[1,0] op_sel_hi:[1,1]
    v_pk_fma_f32 v[54:55], v[32:33], v[184:185], v[54:55] op_sel:[1,1,0] op_sel_hi:[0,1,1] neg_hi:[1,0,0]
    v_pk_mul_f32 v[168:169], v[52:53], v[108:109] op_sel_hi:[1,0]
    v_pk_mul_f32 v[184:185], v[108:109], v[54:55] op_sel:[1,0] op_sel_hi:[1,1]
    v_pk_mul_f32 v[52:53], v[170:171], v[32:33] op_sel:[0,0] op_sel_hi:[0,1]
    v_pk_fma_f32 v[52:53], v[32:33], v[186:187], v[52:53] op_sel:[1,0,0] op_sel_hi:[0,0,1] neg_hi:[1,0,0]
    v_pk_mul_f32 v[54:55], v[170:171], v[32:33] op_sel:[1,0] op_sel_hi:[1,1]
    v_pk_fma_f32 v[54:55], v[32:33], v[186:187], v[54:55] op_sel:[1,1,0] op_sel_hi:[0,1,1] neg_hi:[1,0,0]
    v_pk_mul_f32 v[170:171], v[52:53], v[110:111] op_sel_hi:[1,0]
    v_mfma_f32_16x16x16_bf16 v[200:203], v[92:93], v[84:85], v[200:203]
    v_max_f32 v192, 0, v192
    v_max_f32 v193, 0, v193
    v_mfma_f32_16x16x16_bf16 v[216:219], v[94:95], v[84:85], v[216:219]
    v_max_f32 v194, 0, v194
    v_max_f32 v195, 0, v195
    v_pk_mul_f32 v[192:193], v[120:121], v[192:193] op_sel:[0,0] op_sel_hi:[0,1]
    v_pk_mul_f32 v[194:195], v[120:121], v[194:195] op_sel:[0,0] op_sel_hi:[0,1]
    v_pk_mul_f32 v[192:193], v[192:193], v[192:193]
    v_pk_mul_f32 v[194:195], v[194:195], v[194:195]
    v_cvt_pk_bf16_f32 v132, v192, v193
    v_cvt_pk_bf16_f32 v133, v194, v195
    v_mfma_f32_16x16x16_bf16 v[204:207], v[92:93], v[86:87], v[204:207]
    v_max_f32 v208, 0, v208
    v_max_f32 v209, 0, v209
    v_mfma_f32_16x16x16_bf16 v[220:223], v[94:95], v[86:87], v[220:223]
    v_max_f32 v210, 0, v210
    v_max_f32 v211, 0, v211
    v_pk_mul_f32 v[208:209], v[120:121], v[208:209] op_sel:[0,0] op_sel_hi:[0,1]
    v_pk_mul_f32 v[210:211], v[120:121], v[210:211] op_sel:[0,0] op_sel_hi:[0,1]
    v_pk_mul_f32 v[208:209], v[208:209], v[208:209]
    v_pk_mul_f32 v[210:211], v[210:211], v[210:211]
    v_cvt_pk_bf16_f32 v134, v208, v209
    v_cvt_pk_bf16_f32 v135, v210, v211
    buffer_store_dwordx4 v[132:135], v12, s[56:59], s63 offen sc1
    s_add_u32 s63, s63, 49152
    v_pk_mul_f32 v[186:187], v[110:111], v[54:55] op_sel:[1,0] op_sel_hi:[1,1]
    v_pk_mul_f32 v[52:53], v[172:173], v[32:33] op_sel:[0,0] op_sel_hi:[0,1]
    v_pk_fma_f32 v[52:53], v[32:33], v[188:189], v[52:53] op_sel:[1,0,0] op_sel_hi:[0,0,1] neg_hi:[1,0,0]
    v_pk_mul_f32 v[54:55], v[172:173], v[32:33] op_sel:[1,0] op_sel_hi:[1,1]
    v_pk_fma_f32 v[54:55], v[32:33], v[188:189], v[54:55] op_sel:[1,1,0] op_sel_hi:[0,1,1] neg_hi:[1,0,0]
    v_pk_mul_f32 v[172:173], v[52:53], v[112:113] op_sel_hi:[1,0]
    v_pk_mul_f32 v[188:189], v[112:113], v[54:55] op_sel:[1,0] op_sel_hi:[1,1]
    v_pk_mul_f32 v[52:53], v[174:175], v[32:33] op_sel:[0,0] op_sel_hi:[0,1]
    v_pk_fma_f32 v[52:53], v[32:33], v[190:191], v[52:53] op_sel:[1,0,0] op_sel_hi:[0,0,1] neg_hi:[1,0,0]
    v_pk_mul_f32 v[54:55], v[174:175], v[32:33] op_sel:[1,0] op_sel_hi:[1,1]
    v_pk_fma_f32 v[54:55], v[32:33], v[190:191], v[54:55] op_sel:[1,1,0] op_sel_hi:[0,1,1] neg_hi:[1,0,0]
    v_pk_mul_f32 v[174:175], v[52:53], v[114:115] op_sel_hi:[1,0]
    v_pk_mul_f32 v[190:191], v[114:115], v[54:55] op_sel:[1,0] op_sel_hi:[1,1]
    v_pk_fma_f32 v[58:59], v[20:21], v[160:161], v[176:177] op_sel_hi:[0,1,1]
    v_pk_fma_f32 v[56:57], v[20:21], v[160:161], v[58:59] op_sel:[1,1,0] op_sel_hi:[1,0,1] neg_lo:[1,0,0]
    v_pk_fma_f32 v[58:59], v[20:21], v[56:57], v[162:163] op_sel_hi:[0,1,1]
    v_pk_fma_f32 v[56:57], v[20:21], v[56:57], v[58:59] op_sel:[1,1,0] op_sel_hi:[1,0,1] neg_lo:[1,0,0]
    v_pk_fma_f32 v[58:59], v[20:21], v[56:57], v[178:179] op_sel_hi:[0,1,1]
    v_pk_fma_f32 v[56:57], v[20:21], v[56:57], v[58:59] op_sel:[1,1,0] op_sel_hi:[1,0,1] neg_lo:[1,0,0]
    v_pk_fma_f32 v[58:59], v[20:21], v[56:57], v[164:165] op_sel_hi:[0,1,1]
    v_pk_fma_f32 v[56:57], v[20:21], v[56:57], v[58:59] op_sel:[1,1,0] op_sel_hi:[1,0,1] neg_lo:[1,0,0]
    v_pk_fma_f32 v[58:59], v[20:21], v[56:57], v[180:181] op_sel_hi:[0,1,1]
    v_pk_fma_f32 v[56:57], v[20:21], v[56:57], v[58:59] op_sel:[1,1,0] op_sel_hi:[1,0,1] neg_lo:[1,0,0]
    v_pk_fma_f32 v[58:59], v[20:21], v[56:57], v[166:167] op_sel_hi:[0,1,1]
    v_pk_fma_f32 v[56:57], v[20:21], v[56:57], v[58:59] op_sel:[1,1,0] op_sel_hi:[1,0,1] neg_lo:[1,0,0]
    v_pk_fma_f32 v[58:59], v[20:21], v[56:57], v[182:183] op_sel_hi:[0,1,1]
    v_pk_fma_f32 v[56:57], v[20:21], v[56:57], v[58:59] op_sel:[1,1,0] op_sel_hi:[1,0,1] neg_lo:[1,0,0]
    v_pk_fma_f32 v[58:59], v[20:21], v[56:57], v[168:169] op_sel_hi:[0,1,1]
    v_pk_fma_f32 v[56:57], v[20:21], v[56:57], v[58:59] op_sel:[1,1,0] op_sel_hi:[1,0,1] neg_lo:[1,0,0]
    v_pk_fma_f32 v[58:59], v[20:21], v[56:57], v[184:185] op_sel_hi:[0,1,1]
    v_pk_fma_f32 v[56:57], v[20:21], v[56:57], v[58:59] op_sel:[1,1,0] op_sel_hi:[1,0,1] neg_lo:[1,0,0]
    v_pk_fma_f32 v[58:59], v[20:21], v[56:57], v[170:171] op_sel_hi:[0,1,1]
    v_pk_fma_f32 v[56:57], v[20:21], v[56:57], v[58:59] op_sel:[1,1,0] op_sel_hi:[1,0,1] neg_lo:[1,0,0]
    v_pk_fma_f32 v[58:59], v[20:21], v[56:57], v[186:187] op_sel_hi:[0,1,1]
    v_pk_fma_f32 v[56:57], v[20:21], v[56:57], v[58:59] op_sel:[1,1,0] op_sel_hi:[1,0,1] neg_lo:[1,0,0]
    v_max_f32 v196, 0, v196
    v_max_f32 v197, 0, v197
    v_max_f32 v198, 0, v198
    v_max_f32 v199, 0, v199
    v_pk_mul_f32 v[196:197], v[120:121], v[196:197] op_sel:[1,0] op_sel_hi:[1,1]
    v_pk_mul_f32 v[198:199], v[120:121], v[198:199] op_sel:[1,0] op_sel_hi:[1,1]
    v_pk_mul_f32 v[196:197], v[196:197], v[196:197]
    v_pk_mul_f32 v[198:199], v[198:199], v[198:199]
    v_cvt_pk_bf16_f32 v136, v196, v197
    v_cvt_pk_bf16_f32 v137, v198, v199
    v_max_f32 v212, 0, v212
    v_max_f32 v213, 0, v213
    v_max_f32 v214, 0, v214
    v_max_f32 v215, 0, v215
    v_pk_mul_f32 v[212:213], v[120:121], v[212:213] op_sel:[1,0] op_sel_hi:[1,1]
    v_pk_mul_f32 v[214:215], v[120:121], v[214:215] op_sel:[1,0] op_sel_hi:[1,1]
    v_pk_mul_f32 v[212:213], v[212:213], v[212:213]
    v_pk_mul_f32 v[214:215], v[214:215], v[214:215]
    v_cvt_pk_bf16_f32 v138, v212, v213
    v_cvt_pk_bf16_f32 v139, v214, v215
    buffer_store_dwordx4 v[136:139], v12, s[56:59], s63 offen sc1
    s_add_u32 s63, s63, 49152
    v_pk_fma_f32 v[58:59], v[20:21], v[56:57], v[172:173] op_sel_hi:[0,1,1]
    v_pk_fma_f32 v[56:57], v[20:21], v[56:57], v[58:59] op_sel:[1,1,0] op_sel_hi:[1,0,1] neg_lo:[1,0,0]
    v_pk_fma_f32 v[58:59], v[20:21], v[56:57], v[188:189] op_sel_hi:[0,1,1]
    v_pk_fma_f32 v[56:57], v[20:21], v[56:57], v[58:59] op_sel:[1,1,0] op_sel_hi:[1,0,1] neg_lo:[1,0,0]
    v_pk_fma_f32 v[58:59], v[20:21], v[56:57], v[174:175] op_sel_hi:[0,1,1]
    v_pk_fma_f32 v[56:57], v[20:21], v[56:57], v[58:59] op_sel:[1,1,0] op_sel_hi:[1,0,1] neg_lo:[1,0,0]
    v_pk_fma_f32 v[58:59], v[20:21], v[56:57], v[190:191] op_sel_hi:[0,1,1]
    v_pk_fma_f32 v[56:57], v[20:21], v[56:57], v[58:59] op_sel:[1,1,0] op_sel_hi:[1,0,1] neg_lo:[1,0,0]
    v_mov_b32 v60, v56
    v_mov_b32 v62, v56
    v_mov_b32 v61, v57
    v_mov_b32 v63, v57
    v_permlane16_swap_b32 v60, v62
    s_nop 0
    v_permlane16_swap_b32 v61, v63
    v_mov_b32 v64, v60
    v_mov_b32 v66, v62
    v_mov_b32 v65, v61
    v_mov_b32_e64 v67, v63
    v_permlane32_swap_b32 v60, v64
    v_permlane32_swap_b32 v62, v66
    v_permlane32_swap_b32 v61, v65
    v_permlane32_swap_b32 v63, v67
    v_pk_fma_f32 v[58:59], v[22:23], v[60:61], v[62:63] op_sel_hi:[0,1,1]
    v_pk_fma_f32 v[62:63], v[22:23], v[60:61], v[58:59] op_sel:[1,1,0] op_sel_hi:[1,0,1] neg_lo:[1,0,0]
    v_pk_fma_f32 v[58:59], v[22:23], v[62:63], v[64:65] op_sel_hi:[0,1,1]
    v_pk_fma_f32 v[64:65], v[22:23], v[62:63], v[58:59] op_sel:[1,1,0] op_sel_hi:[1,0,1] neg_lo:[1,0,0]
    v_pk_fma_f32 v[58:59], v[22:23], v[64:65], v[66:67] op_sel_hi:[0,1,1]
    v_pk_fma_f32 v[72:73], v[22:23], v[64:65], v[58:59] op_sel:[1,1,0] op_sel_hi:[1,0,1] neg_lo:[1,0,0]
    s_cmp_eq_u32 s74, 0
    s_cbranch_scc0 L_nw_48
    ds_write_b64 v10, v[72:73] offset:3360
L_nw_48:
    s_mov_b64 exec, 0xffff
    v_mov_b32 v48, 0
    v_mov_b32 v49, 0
    s_lshl_b64 exec, exec, 16
    v_mov_b32 v48, v60
    v_mov_b32 v49, v61
    s_lshl_b64 exec, exec, 16
    v_mov_b32 v48, v62
    v_mov_b32 v49, v63
    s_lshl_b64 exec, exec, 16
    v_mov_b32 v48, v64
    v_mov_b32 v49, v65
    s_mov_b64 exec, -1
    s_lshl2_add_u32 s4, s75, 81920
    v_mov_b32 v57, s4
    s_cmp_eq_u32 s74, 0
    s_cbranch_scc0 L_pb_49
    v_mov_b32 v56, 1
    ds_write_b32 v57, v56 offset:3088
    s_branch L_pe_50
L_pb_49:
    s_mov_b32 s38, 0
L_pt_51:
    ds_read_b32 v56, v57 offset:3088
    ds_read_b64 v[52:53], v10 offset:3360
    s_waitcnt lgkmcnt(0)
    v_cmp_gt_u32 vcc, 1, v56
    s_cbranch_vccz L_pt_51d
    s_add_u32 s38, s38, 1
    s_cmp_lt_u32 s38, 0x800000
    s_cbranch_scc0 L_pt_51d
    s_branch L_pt_51
L_pt_51d:
    v_pk_fma_f32 v[58:59], v[24:25], v[52:53], v[72:73] op_sel_hi:[0,1,1]
    v_pk_fma_f32 v[72:73], v[24:25], v[52:53], v[58:59] op_sel:[1,1,0] op_sel_hi:[1,0,1] neg_lo:[1,0,0]
    v_mov_b32 v60, v72
    v_mov_b32 v61, s51
    v_mov_b32 v62, v73
    v_mov_b32 v63, s51
    s_mov_b64 exec, 0xffff
    buffer_store_dwordx4 v[60:63], v17, s[56:59], 0 offen offset:0 sc1
    s_mov_b64 exec, -1
L_pe_50:
    v_max_f32 v200, 0, v200
    v_max_f32 v201, 0, v201
    v_max_f32 v202, 0, v202
    v_max_f32_e64 v203, 0, v203
    v_pk_mul_f32 v[200:201], v[122:123], v[200:201] op_sel:[0,0] op_sel_hi:[0,1]
    v_pk_mul_f32 v[202:203], v[122:123], v[202:203] op_sel:[0,0] op_sel_hi:[0,1]
    v_pk_mul_f32 v[200:201], v[200:201], v[200:201]
    v_pk_mul_f32 v[202:203], v[202:203], v[202:203]
    v_cvt_pk_bf16_f32 v140, v200, v201
    v_cvt_pk_bf16_f32 v141, v202, v203
    v_max_f32 v216, 0, v216
    v_max_f32 v217, 0, v217
    v_max_f32 v218, 0, v218
    v_max_f32 v219, 0, v219
    v_pk_mul_f32 v[216:217], v[122:123], v[216:217] op_sel:[0,0] op_sel_hi:[0,1]
    v_pk_mul_f32 v[218:219], v[122:123], v[218:219] op_sel:[0,0] op_sel_hi:[0,1]
    v_pk_mul_f32 v[216:217], v[216:217], v[216:217]
    v_pk_mul_f32 v[218:219], v[218:219], v[218:219]
    v_cvt_pk_bf16_f32 v142, v216, v217
    v_cvt_pk_bf16_f32 v143, v218, v219
    buffer_store_dwordx4 v[140:143], v12, s[56:59], s63 offen sc1
    s_add_u32 s63, s63, 49152
    v_max_f32 v204, 0, v204
    v_max_f32 v205, 0, v205
    v_max_f32 v206, 0, v206
    v_max_f32 v207, 0, v207
    v_pk_mul_f32 v[204:205], v[122:123], v[204:205] op_sel:[1,0] op_sel_hi:[1,1]
    v_pk_mul_f32 v[206:207], v[122:123], v[206:207] op_sel:[1,0] op_sel_hi:[1,1]
    v_pk_mul_f32 v[204:205], v[204:205], v[204:205]
    v_pk_mul_f32 v[206:207], v[206:207], v[206:207]
    v_cvt_pk_bf16_f32 v144, v204, v205
    v_cvt_pk_bf16_f32 v145, v206, v207
    v_max_f32 v220, 0, v220
    v_max_f32 v221, 0, v221
    v_max_f32 v222, 0, v222
    v_max_f32 v223, 0, v223
    v_pk_mul_f32 v[220:221], v[122:123], v[220:221] op_sel:[1,0] op_sel_hi:[1,1]
    v_pk_mul_f32 v[222:223], v[122:123], v[222:223] op_sel:[1,0] op_sel_hi:[1,1]
    v_pk_mul_f32 v[220:221], v[220:221], v[220:221]
    v_pk_mul_f32 v[222:223], v[222:223], v[222:223]
    v_cvt_pk_bf16_f32 v146, v220, v221
    v_cvt_pk_bf16_f32 v147, v222, v223
    buffer_store_dwordx4 v[144:147], v12, s[56:59], s63 offen sc1
    s_add_u32 s63, s63, 49152
    s_barrier
    v_mul_u32_u24 v120, 40960, v2
    v_sub_u32 v120, v17, v120
    v_subrev_u32 v123, 40960, v120
    v_subrev_u32 v122, 30720, v120
    v_subrev_u32 v121, 20480, v120
    v_subrev_u32 v120, 10240, v120
    v_ashrrev_i32_e64 v124, 31, v120
    v_bfi_b32 v124, v124, 0, s51
    v_ashrrev_i32_e64 v125, 31, v121
    v_bfi_b32 v125, v125, 0, s51
    v_ashrrev_i32_e64 v126, 31, v122
    v_bfi_b32 v126, v126, 0, s51
    v_ashrrev_i32_e64 v127, 31, v123
    v_bfi_b32 v127, v127, 0, s51
    s_mov_b32 s38, 0
    s_waitcnt vmcnt(0)
    s_mov_b64 exec, 1
    v_mov_b32 v76, 81920
    v_mov_b32 v77, 1
    ds_add_rtn_u32 v77, v76, v77 offset:3104
    s_mov_b64 exec, -1
    s_waitcnt lgkmcnt(0)
    v_readfirstlane_b32 s4, v77
    s_cmp_eq_u32 s4, 3
    s_cbranch_scc0 L_arr_55
    s_mov_b32 exec_hi, 0
    s_mov_b32 s4, 0
    s_nop 0
    buffer_store_dword v19, v18, s[56:59], s4 offen sc1
    s_mov_b32 exec_hi, -1
L_arr_55:
    buffer_load_dwordx4 v[80:83], v120, s[56:59], 0 offen offset:0 sc1
    buffer_load_dwordx4 v[84:87], v121, s[56:59], 0 offen offset:0 sc1
    buffer_load_dwordx4 v[88:91], v122, s[56:59], 0 offen offset:0 sc1
    buffer_load_dwordx4 v[92:95], v123, s[56:59], 0 offen offset:0 sc1
    s_branch L_lbc_54
L_lb_52:
    buffer_load_dwordx4 v[80:83], v120, s[56:59], 0 offen offset:0 sc1
    buffer_load_dwordx4 v[84:87], v121, s[56:59], 0 offen offset:0 sc1
    buffer_load_dwordx4 v[88:91], v122, s[56:59], 0 offen offset:0 sc1
    buffer_load_dwordx4 v[92:95], v123, s[56:59], 0 offen offset:0 sc1
L_lbc_54:
    s_waitcnt vmcnt(0)
    v_xor_b32 v81, v81, v124
    v_xor_b32 v83, v83, v124
    v_or_b32 v58, v81, v83
    v_xor_b32 v85, v85, v125
    v_xor_b32 v87, v87, v125
    v_or3_b32 v58, v58, v85, v87
    v_xor_b32 v89, v89, v126
    v_xor_b32 v91, v91, v126
    v_or3_b32 v58, v58, v89, v91
    v_xor_b32 v93, v93, v127
    v_xor_b32 v95, v95, v127
    v_or3_b32 v58, v58, v93, v95
    v_cmp_ne_u32 vcc, 0, v58
    s_cbranch_vccz L_lbd_53
    s_add_u32 s38, s38, 1
    s_cmp_lt_u32 s38, 0x40000
    s_cbranch_scc0 L_lbd_53
    s_sleep 4
    s_branch L_lb_52
L_lbd_53:
    v_mov_b32 v81, v82
    v_mov_b32 v85, v86
    v_mov_b32 v89, v90
    v_mov_b32 v93, v94
    v_fmac_f32 v88, v26, v92
    v_fmac_f32 v89, v26, v93
    v_fma_f32 v88, -v27, v93, v88
    v_fmac_f32 v89, v27, v92
    v_fmac_f32 v84, v26, v88
    v_fmac_f32_e64 v85, v26, v89
    v_fma_f32 v84, -v27, v89, v84
    v_fmac_f32 v85, v27, v88
    v_fmac_f32 v80, v26, v84
    v_fmac_f32_e64 v81, v26, v85
    v_fma_f32 v80, -v27, v85, v80
    v_fmac_f32 v81, v27, v84
    v_mul_f32 v56, v30, v80
    v_mul_f32_e64 v57, v30, v81
    v_fma_f32 v56, -v31, v81, v56
    v_fmac_f32 v57, v31, v80
    v_mov_b32 v58, v56
    v_mov_b32 v59, v57
    s_nop 0
    v_permlane16_swap_b32 v56, v58
    v_permlane16_swap_b32 v57, v59
    v_add_f32 v56, v56, v58
    v_add_f32 v57, v57, v59
    v_mov_b32 v58, v56
    v_mov_b32 v59, v57
    s_nop 0
    v_permlane32_swap_b32 v56, v58
    v_permlane32_swap_b32 v57, v59
    v_add_f32 v56, v56, v58
    v_add_f32 v57, v57, v59
    s_cmp_eq_u32 s74, 0
    s_cbranch_scc1 L_w0_56
    v_fmac_f32 v52, v24, v56
    v_fmac_f32_e64 v53, v24, v57
    v_fma_f32 v52, -v25, v57, v52
    v_fmac_f32 v53, v25, v56
    v_mov_b32 v56, v52
    v_mov_b32 v57, v53
L_w0_56:
    v_fmac_f32 v48, v28, v56
    v_fmac_f32_e64 v49, v28, v57
    v_fma_f32 v48, -v29, v57, v48
    v_fmac_f32 v49, v29, v56
    v_fmac_f32 v160, v20, v48
    v_fmac_f32_e64 v161, v20, v49
    v_fma_f32 v160, -v21, v49, v160
    v_fmac_f32 v161, v21, v48
    v_fmac_f32 v176, v20, v160
    v_fmac_f32_e64 v177, v20, v161
    v_fma_f32 v176, -v21, v161, v176
    v_fmac_f32 v177, v21, v160
    v_fmac_f32 v162, v20, v176
    v_fmac_f32_e64 v163, v20, v177
    v_fma_f32 v162, -v21, v177, v162
    v_fmac_f32 v163, v21, v176
    v_fmac_f32 v178, v20, v162
    v_fmac_f32_e64 v179, v20, v163
    v_fma_f32 v178, -v21, v163, v178
    v_fmac_f32 v179, v21, v162
    v_fmac_f32 v164, v20, v178
    v_fmac_f32_e64 v165, v20, v179
    v_fma_f32 v164, -v21, v179, v164
    v_fmac_f32 v165, v21, v178
    v_fmac_f32 v180, v20, v164
    v_fmac_f32_e64 v181, v20, v165
    v_fma_f32 v180, -v21, v165, v180
    v_fmac_f32 v181, v21, v164
    v_fmac_f32 v166, v20, v180
    v_fmac_f32_e64 v167, v20, v181
    v_fma_f32 v166, -v21, v181, v166
    v_fmac_f32 v167, v21, v180
    v_fmac_f32 v182, v20, v166
    v_fmac_f32_e64 v183, v20, v167
    v_fma_f32 v182, -v21, v167, v182
    v_fmac_f32 v183, v21, v166
    v_fmac_f32 v168, v20, v182
    v_fmac_f32_e64 v169, v20, v183
    v_fma_f32 v168, -v21, v183, v168
    v_fmac_f32 v169, v21, v182
    v_fmac_f32 v184, v20, v168
    v_fmac_f32_e64 v185, v20, v169
    v_fma_f32 v184, -v21, v169, v184
    v_fmac_f32 v185, v21, v168
    v_fmac_f32 v170, v20, v184
    v_fmac_f32_e64 v171, v20, v185
    v_fma_f32 v170, -v21, v185, v170
    v_fmac_f32 v171, v21, v184
    v_fmac_f32 v186, v20, v170
    v_fmac_f32_e64 v187, v20, v171
    v_fma_f32 v186, -v21, v171, v186
    v_fmac_f32 v187, v21, v170
    v_fmac_f32 v172, v20, v186
    v_fmac_f32_e64 v173, v20, v187
    v_fma_f32 v172, -v21, v187, v172
    v_fmac_f32 v173, v21, v186
    v_fmac_f32 v188, v20, v172
    v_fmac_f32_e64 v189, v20, v173
    v_fma_f32 v188, -v21, v173, v188
    v_fmac_f32 v189, v21, v172
    v_fmac_f32 v174, v20, v188
    v_fmac_f32_e64 v175, v20, v189
    v_fma_f32 v174, -v21, v189, v174
    v_fmac_f32 v175, v21, v188
    v_fmac_f32 v190, v20, v174
    v_fmac_f32_e64 v191, v20, v175
    v_fma_f32 v190, -v21, v175, v190
    v_fmac_f32_e64 v191, v21, v174
    v_cvt_pk_bf16_f32 v128, v160, v176
    v_cvt_pk_bf16_f32 v129, v162, v178
    v_cvt_pk_bf16_f32 v130, v164, v180
    v_cvt_pk_bf16_f32 v131, v166, v182
    ds_write_b128 v14, v[128:131] offset:0
    v_cvt_pk_bf16_f32 v132, v168, v184
    v_cvt_pk_bf16_f32 v133, v170, v186
    v_cvt_pk_bf16_f32 v134, v172, v188
    v_cvt_pk_bf16_f32 v135, v174, v190
    ds_write_b128 v14, v[132:135] offset:1024
    v_cvt_pk_bf16_f32 v136, v161, v177
    v_cvt_pk_bf16_f32 v137, v163, v179
    v_cvt_pk_bf16_f32 v138, v165, v181
    v_cvt_pk_bf16_f32 v139, v167, v183
    ds_write_b128 v14, v[136:139] offset:2048
    v_cvt_pk_bf16_f32 v140, v169, v185
    v_cvt_pk_bf16_f32 v141, v171, v187
    v_cvt_pk_bf16_f32 v142, v173, v189
    v_cvt_pk_bf16_f32 v143, v175, v191
    ds_write_b128 v14, v[140:143] offset:3072
    ds_read_b64_tr_b16 v[144:145], v15 offset:0
    ds_read_b64_tr_b16 v[146:147], v16 offset:0
    ds_read_b64_tr_b16 v[148:149], v15 offset:8
    ds_read_b64_tr_b16 v[150:151], v16 offset:8
    ds_read_b64_tr_b16 v[152:153], v15 offset:1024
    ds_read_b64_tr_b16 v[154:155], v16 offset:1024
    ds_read_b64_tr_b16 v[156:157], v15 offset:1032
    ds_read_b64_tr_b16 v[158:159], v16 offset:1032
    s_mul_i32 s5, s53, 10
    s_sub_u32 s4, s45, s5
    s_add_u32 s4, s4, 0
    s_and_b32 s5, s4, -2
    s_add_u32 s4, s4, s5
    s_add_u32 s4, s4, 28
    s_lshl_b32 s4, s4, 10
    s_add_u32 s4, s4, s39
    s_waitcnt lgkmcnt(6)
    buffer_store_dwordx4 v[144:147], v13, s[56:59], s4 offen sc1
    s_add_u32 s4, s4, 49152
    s_waitcnt lgkmcnt(4)
    buffer_store_dwordx4 v[148:151], v13, s[56:59], s4 offen sc1
    s_add_u32 s4, s4, 49152
    s_waitcnt lgkmcnt(2)
    buffer_store_dwordx4 v[152:155], v13, s[56:59], s4 offen sc1
    s_add_u32 s4, s4, 49152
    s_waitcnt lgkmcnt(0)
    buffer_store_dwordx4 v[156:159], v13, s[56:59], s4 offen sc1
    s_add_u32 s4, s4, 49152
    s_branch L_ctail
L_typeB:
    s_barrier
    ds_read_b128 v[80:83], v3 offset:0
    ds_read_b128 v[84:87], v3 offset:2048
    ds_read_b128 v[88:91], v3 offset:4096
    ds_read_b128 v[92:95], v3 offset:6144
    ds_read_b128 v[96:99], v5 offset:16384
    ds_read_b128 v[100:103], v5 offset:20480
    ds_read_b128 v[104:107], v5 offset:24576
    ds_read_b128 v[108:111], v5 offset:28672
    ds_read_b64_tr_b16 v[112:113], v7 offset:32768
    ds_read_b64_tr_b16 v[114:115], v7 offset:33280
    ds_read_b64_tr_b16 v[116:117], v8 offset:32768
    ds_read_b64_tr_b16 v[118:119], v8 offset:33280
    s_branch L_midB
.p2align 4
L_topB:
    s_waitcnt lgkmcnt(0)
    s_barrier
    v_mfma_f32_16x16x32_bf16 v[160:163], v[120:123], v[136:139], v[160:163]
    ds_read_b128 v[80:83], v3 offset:0
    v_mfma_f32_16x16x32_bf16 v[164:167], v[124:127], v[136:139], v[164:167]
    ds_read_b128 v[84:87], v3 offset:2048
    v_mfma_f32_16x16x32_bf16 v[168:171], v[128:131], v[136:139], v[168:171]
    ds_read_b128 v[88:91], v3 offset:4096
    v_mfma_f32_16x16x32_bf16 v[172:175], v[132:135], v[136:139], v[172:175]
    ds_read_b128 v[92:95], v3 offset:6144
    v_mfma_f32_16x16x32_bf16 v[188:191], v[132:135], v[140:143], v[188:191]
    ds_read_b128 v[96:99], v5 offset:16384
    v_mfma_f32_16x16x32_bf16 v[184:187], v[128:131], v[140:143], v[184:187]
    ds_read_b128 v[100:103], v5 offset:20480
    v_mfma_f32_16x16x32_bf16 v[180:183], v[124:127], v[140:143], v[180:183]
    ds_read_b128 v[104:107], v5 offset:24576
    v_mfma_f32_16x16x32_bf16 v[176:179], v[120:123], v[140:143], v[176:179]
    ds_read_b128 v[108:111], v5 offset:28672
    v_mfma_f32_16x16x32_bf16 v[192:195], v[120:123], v[144:147], v[192:195]
    ds_read_b64_tr_b16 v[112:113], v7 offset:32768
    v_mfma_f32_16x16x32_bf16 v[196:199], v[124:127], v[144:147], v[196:199]
    ds_read_b64_tr_b16 v[114:115], v7 offset:33280
    v_mfma_f32_16x16x32_bf16 v[200:203], v[128:131], v[144:147], v[200:203]
    ds_read_b64_tr_b16 v[116:117], v8 offset:32768
    v_mfma_f32_16x16x32_bf16 v[204:207], v[132:135], v[144:147], v[204:207]
    ds_read_b64_tr_b16 v[118:119], v8 offset:33280
    v_mfma_f32_16x16x32_bf16 v[220:223], v[132:135], v[148:151], v[220:223]
    v_mfma_f32_16x16x32_bf16 v[216:219], v[128:131], v[148:151], v[216:219]
    v_mfma_f32_16x16x32_bf16 v[212:215], v[124:127], v[148:151], v[212:215]
    v_mfma_f32_16x16x32_bf16 v[208:211], v[120:123], v[148:151], v[208:211]
    v_mfma_f32_16x16x32_bf16 v[224:227], v[152:155], v[120:123], v[224:227]
    v_mfma_f32_16x16x32_bf16 v[228:231], v[152:155], v[124:127], v[228:231]
    v_mfma_f32_16x16x32_bf16 v[232:235], v[152:155], v[128:131], v[232:235]
    v_mfma_f32_16x16x32_bf16 v[236:239], v[152:155], v[132:135], v[236:239]
    v_mfma_f32_16x16x32_bf16 v[252:255], v[156:159], v[132:135], v[252:255]
    v_mfma_f32_16x16x32_bf16 v[248:251], v[156:159], v[128:131], v[248:251]
    v_mfma_f32_16x16x32_bf16 v[244:247], v[156:159], v[124:127], v[244:247]
    v_mfma_f32_16x16x32_bf16 v[240:243], v[156:159], v[120:123], v[240:243]
L_midB:
    s_waitcnt lgkmcnt(0)
    s_and_b32 s4, s38, 3
    v_mfma_f32_16x16x32_bf16 v[160:163], v[80:83], v[96:99], v[160:163]
    ds_read_b128 v[120:123], v4 offset:0
    v_mfma_f32_16x16x32_bf16 v[164:167], v[84:87], v[96:99], v[164:167]
    ds_read_b128 v[124:127], v4 offset:2048
    v_mfma_f32_16x16x32_bf16 v[168:171], v[88:91], v[96:99], v[168:171]
    ds_read_b128 v[128:131], v4 offset:4096
    v_mfma_f32_16x16x32_bf16 v[172:175], v[92:95], v[96:99], v[172:175]
    ds_read_b128 v[132:135], v4 offset:6144
    v_mfma_f32_16x16x32_bf16 v[188:191], v[92:95], v[100:103], v[188:191]
    ds_read_b128 v[136:139], v6 offset:16384
    v_mfma_f32_16x16x32_bf16 v[184:187], v[88:91], v[100:103], v[184:187]
    ds_read_b128 v[140:143], v6 offset:20480
    v_mfma_f32_16x16x32_bf16 v[180:183], v[84:87], v[100:103], v[180:183]
    ds_read_b128 v[144:147], v6 offset:24576
    v_mfma_f32_16x16x32_bf16 v[176:179], v[80:83], v[100:103], v[176:179]
    ds_read_b128 v[148:151], v6 offset:28672
    v_mfma_f32_16x16x32_bf16 v[192:195], v[80:83], v[104:107], v[192:195]
    ds_read_b64_tr_b16 v[152:153], v7 offset:36864
    v_mfma_f32_16x16x32_bf16 v[196:199], v[84:87], v[104:107], v[196:199]
    ds_read_b64_tr_b16 v[154:155], v7 offset:37376
    v_mfma_f32_16x16x32_bf16 v[200:203], v[88:91], v[104:107], v[200:203]
    ds_read_b64_tr_b16 v[156:157], v8 offset:36864
    v_mfma_f32_16x16x32_bf16 v[204:207], v[92:95], v[104:107], v[204:207]
    ds_read_b64_tr_b16 v[158:159], v8 offset:37376
    v_mfma_f32_16x16x32_bf16 v[220:223], v[92:95], v[108:111], v[220:223]
    s_cmp_eq_u32 s4, 3
    s_cselect_b32 s27, s6, s7
    v_add_u32_e64 v3, s27, v3
    v_mfma_f32_16x16x32_bf16 v[216:219], v[88:91], v[108:111], v[216:219]
    v_add_u32_e64 v4, s27, v4
    v_mfma_f32_16x16x32_bf16 v[212:215], v[84:87], v[108:111], v[212:215]
    v_add_u32_e64 v5, s27, v5
    v_mfma_f32_16x16x32_bf16 v[208:211], v[80:83], v[108:111], v[208:211]
    v_add_u32_e64 v6, s27, v6
    v_mfma_f32_16x16x32_bf16 v[224:227], v[112:115], v[80:83], v[224:227]
    v_add_u32_e64 v7, s27, v7
    v_mfma_f32_16x16x32_bf16 v[228:231], v[112:115], v[84:87], v[228:231]
    v_add_u32_e64 v8, s27, v8
    v_mfma_f32_16x16x32_bf16 v[232:235], v[112:115], v[88:91], v[232:235]
    s_add_u32 s38, s38, 1
    s_cmp_lt_u32 s38, 10
    v_mfma_f32_16x16x32_bf16 v[236:239], v[112:115], v[92:95], v[236:239]
    v_mfma_f32_16x16x32_bf16 v[252:255], v[116:119], v[92:95], v[252:255]
    v_mfma_f32_16x16x32_bf16 v[248:251], v[116:119], v[88:91], v[248:251]
    v_mfma_f32_16x16x32_bf16 v[244:247], v[116:119], v[84:87], v[244:247]
    v_mfma_f32_16x16x32_bf16 v[240:243], v[116:119], v[80:83], v[240:243]
    s_cbranch_scc1 L_topB
    s_waitcnt lgkmcnt(0)
    v_mfma_f32_16x16x32_bf16 v[160:163], v[120:123], v[136:139], v[160:163]
    v_mov_b32 v88, 0
    v_mov_b32 v89, 0
    v_mfma_f32_16x16x32_bf16 v[164:167], v[124:127], v[136:139], v[164:167]
    v_mov_b32 v90, 0
    v_mov_b32 v91, 0
    v_mfma_f32_16x16x32_bf16 v[168:171], v[128:131], v[136:139], v[168:171]
    v_mov_b32 v92, 0
    v_mov_b32 v93, 0
    v_mfma_f32_16x16x32_bf16 v[172:175], v[132:135], v[136:139], v[172:175]
    v_mov_b32 v94, 0
    v_mov_b32 v95, 0
    v_mfma_f32_16x16x32_bf16 v[188:191], v[132:135], v[140:143], v[188:191]
    v_mov_b32 v96, 0
    v_mov_b32 v97, 0
    v_mfma_f32_16x16x32_bf16 v[184:187], v[128:131], v[140:143], v[184:187]
    v_mov_b32 v98, 0
    v_mov_b32 v99, 0
    v_mfma_f32_16x16x32_bf16 v[180:183], v[124:127], v[140:143], v[180:183]
    s_mov_b64 exec, 0xffff
    ds_read_b64 v[88:89], v10 offset:1024
    s_mov_b64 exec, -1
    v_mfma_f32_16x16x32_bf16 v[176:179], v[120:123], v[140:143], v[176:179]
    s_mov_b64 exec, 0xffff
    ds_read_b64 v[90:91], v10 offset:1152
    s_mov_b64 exec, -1
    v_mfma_f32_16x16x32_bf16 v[192:195], v[120:123], v[144:147], v[192:195]
    s_mov_b64 exec, 0xffff
    ds_read_b64 v[92:93], v10 offset:1536
    s_mov_b64 exec, -1
    v_mfma_f32_16x16x32_bf16 v[196:199], v[124:127], v[144:147], v[196:199]
    s_mov_b64 exec, 0xffff
    ds_read_b64 v[94:95], v10 offset:1664
    s_mov_b64 exec, -1
    v_mfma_f32_16x16x32_bf16 v[200:203], v[128:131], v[144:147], v[200:203]
    s_mov_b64 exec, 0xffff
    ds_read_b64 v[96:97], v10 offset:2048
    s_mov_b64 exec, -1
    v_mfma_f32_16x16x32_bf16 v[204:207], v[132:135], v[144:147], v[204:207]
    s_mov_b64 exec, 0xffff
    ds_read_b64 v[98:99], v10 offset:2176
    s_mov_b64 exec, -1
    v_mfma_f32_16x16x32_bf16 v[220:223], v[132:135], v[148:151], v[220:223]
    ds_read_b64 v[80:81], v9 offset:0
    v_mfma_f32_16x16x32_bf16 v[216:219], v[128:131], v[148:151], v[216:219]
    ds_read_b64 v[82:83], v9 offset:128
    v_mfma_f32_16x16x32_bf16 v[212:215], v[124:127], v[148:151], v[212:215]
    ds_read_b64 v[84:85], v9 offset:256
    v_mfma_f32_16x16x32_bf16 v[208:211], v[120:123], v[148:151], v[208:211]
    ds_read_b64 v[86:87], v9 offset:384
    v_mfma_f32_16x16x32_bf16 v[224:227], v[152:155], v[120:123], v[224:227]
    ds_read_b128 v[100:103], v11 offset:2560
    v_mfma_f32_16x16x32_bf16 v[228:231], v[152:155], v[124:127], v[228:231]
    ds_read_b128 v[104:107], v11 offset:2576
    v_mfma_f32_16x16x32_bf16 v[232:235], v[152:155], v[128:131], v[232:235]
    ds_read_b128 v[108:111], v11 offset:2592
    v_mfma_f32_16x16x32_bf16 v[236:239], v[152:155], v[132:135], v[236:239]
    ds_read_b128 v[112:115], v11 offset:2608
    v_mfma_f32_16x16x32_bf16 v[252:255], v[156:159], v[132:135], v[252:255]
    v_mfma_f32_16x16x32_bf16 v[248:251], v[156:159], v[128:131], v[248:251]
    v_mfma_f32_16x16x32_bf16 v[244:247], v[156:159], v[124:127], v[244:247]
    v_mfma_f32_16x16x32_bf16 v[240:243], v[156:159], v[120:123], v[240:243]
    s_waitcnt lgkmcnt(0)
    v_mfma_f32_16x16x16_bf16 v[160:163], v[80:81], v[88:89], v[160:163]
    v_and_b32 v120, 0xffff0000, v81
    v_rcp_f32 v120, v120
    v_mfma_f32_16x16x16_bf16 v[176:179], v[80:81], v[90:91], v[176:179]
    v_and_b32 v121, 0xffff0000, v83
    v_rcp_f32_e64 v121, v121
    v_mfma_f32_16x16x16_bf16 v[164:167], v[82:83], v[88:89], v[164:167]
    v_and_b32 v122, 0xffff0000, v85
    v_rcp_f32_e64 v122, v122
    v_mfma_f32_16x16x16_bf16 v[180:183], v[82:83], v[90:91], v[180:183]
    v_and_b32 v123, 0xffff0000, v87
    v_rcp_f32_e64 v123, v123
    v_mfma_f32_16x16x16_bf16 v[168:171], v[84:85], v[88:89], v[168:171]
    v_mfma_f32_16x16x16_bf16 v[184:187], v[84:85], v[90:91], v[184:187]
    v_mfma_f32_16x16x16_bf16 v[172:175], v[86:87], v[88:89], v[172:175]
    v_mfma_f32_16x16x16_bf16 v[188:191], v[86:87], v[90:91], v[188:191]
    v_mfma_f32_16x16x16_bf16 v[192:195], v[80:81], v[92:93], v[192:195]
    v_mfma_f32_16x16x16_bf16 v[208:211], v[80:81], v[94:95], v[208:211]
    v_mfma_f32_16x16x16_bf16 v[196:199], v[82:83], v[92:93], v[196:199]
    v_mfma_f32_16x16x16_bf16 v[212:215], v[82:83], v[94:95], v[212:215]
    v_mfma_f32_16x16x16_bf16 v[200:203], v[84:85], v[92:93], v[200:203]
    v_mfma_f32_16x16x16_bf16 v[216:219], v[84:85], v[94:95], v[216:219]
    v_mfma_f32_16x16x16_bf16 v[204:207], v[86:87], v[92:93], v[204:207]
    v_mfma_f32_16x16x16_bf16 v[220:223], v[86:87], v[94:95], v[220:223]
    v_mfma_f32_16x16x16_bf16 v[224:227], v[96:97], v[80:81], v[224:227]
    v_mfma_f32_16x16x16_bf16 v[240:243], v[98:99], v[80:81], v[240:243]
    v_mfma_f32_16x16x16_bf16 v[228:231], v[96:97], v[82:83], v[228:231]
    v_mfma_f32_16x16x16_bf16 v[244:247], v[98:99], v[82:83], v[244:247]
    v_pk_mul_f32 v[52:53], v[160:161], v[32:33] op_sel:[0,0] op_sel_hi:[0,1]
    v_pk_fma_f32 v[52:53], v[32:33], v[176:177], v[52:53] op_sel:[1,0,0] op_sel_hi:[0,0,1] neg_hi:[1,0,0]
    v_pk_mul_f32 v[54:55], v[160:161], v[32:33] op_sel:[1,0] op_sel_hi:[1,1]
    v_pk_fma_f32 v[54:55], v[32:33], v[176:177], v[54:55] op_sel:[1,1,0] op_sel_hi:[0,1,1] neg_hi:[1,0,0]
    v_pk_mul_f32 v[160:161], v[52:53], v[100:101] op_sel_hi:[1,0]
    v_pk_mul_f32 v[176:177], v[100:101], v[54:55] op_sel:[1,0] op_sel_hi:[1,1]
    v_pk_mul_f32 v[52:53], v[162:163], v[32:33] op_sel:[0,0] op_sel_hi:[0,1]
    v_pk_fma_f32 v[52:53], v[32:33], v[178:179], v[52:53] op_sel:[1,0,0] op_sel_hi:[0,0,1] neg_hi:[1,0,0]
    v_pk_mul_f32 v[54:55], v[162:163], v[32:33] op_sel:[1,0] op_sel_hi:[1,1]
    v_pk_fma_f32 v[54:55], v[32:33], v[178:179], v[54:55] op_sel:[1,1,0] op_sel_hi:[0,1,1] neg_hi:[1,0,0]
    v_pk_mul_f32 v[162:163], v[52:53], v[102:103] op_sel_hi:[1,0]
    v_pk_mul_f32 v[178:179], v[102:103], v[54:55] op_sel:[1,0] op_sel_hi:[1,1]
    v_pk_mul_f32 v[52:53], v[164:165], v[32:33] op_sel:[0,0] op_sel_hi:[0,1]
    v_pk_fma_f32 v[52:53], v[32:33], v[180:181], v[52:53] op_sel:[1,0,0] op_sel_hi:[0,0,1] neg_hi:[1,0,0]
    v_pk_mul_f32 v[54:55], v[164:165], v[32:33] op_sel:[1,0] op_sel_hi:[1,1]
    v_pk_fma_f32 v[54:55], v[32:33], v[180:181], v[54:55] op_sel:[1,1,0] op_sel_hi:[0,1,1] neg_hi:[1,0,0]
    v_pk_mul_f32 v[164:165], v[52:53], v[104:105] op_sel_hi:[1,0]
    v_pk_mul_f32 v[180:181], v[104:105], v[54:55] op_sel:[1,0] op_sel_hi:[1,1]
    v_pk_mul_f32 v[52:53], v[166:167], v[32:33] op_sel:[0,0] op_sel_hi:[0,1]
    v_pk_fma_f32 v[52:53], v[32:33], v[182:183], v[52:53] op_sel:[1,0,0] op_sel_hi:[0,0,1] neg_hi:[1,0,0]
    v_pk_mul_f32 v[54:55], v[166:167], v[32:33] op_sel:[1,0] op_sel_hi:[1,1]
    v_pk_fma_f32 v[54:55], v[32:33], v[182:183], v[54:55] op_sel:[1,1,0] op_sel_hi:[0,1,1] neg_hi:[1,0,0]
    v_pk_mul_f32 v[166:167], v[52:53], v[106:107] op_sel_hi:[1,0]
    v_pk_mul_f32 v[182:183], v[106:107], v[54:55] op_sel:[1,0] op_sel_hi:[1,1]
    v_pk_mul_f32 v[52:53], v[168:169], v[32:33] op_sel:[0,0] op_sel_hi:[0,1]
    v_pk_fma_f32 v[52:53], v[32:33], v[184:185], v[52:53] op_sel:[1,0,0] op_sel_hi:[0,0,1] neg_hi:[1,0,0]
    v_pk_mul_f32 v[54:55], v[168:169], v[32:33] op_sel:[1,0] op_sel_hi:[1,1]
    v_pk_fma_f32 v[54:55], v[32:33], v[184:185], v[54:55] op_sel:[1,1,0] op_sel_hi:[0,1,1] neg_hi:[1,0,0]
    v_pk_mul_f32 v[168:169], v[52:53], v[108:109] op_sel_hi:[1,0]
    v_pk_mul_f32 v[184:185], v[108:109], v[54:55] op_sel:[1,0] op_sel_hi:[1,1]
    v_pk_mul_f32 v[52:53], v[170:171], v[32:33] op_sel:[0,0] op_sel_hi:[0,1]
    v_pk_fma_f32 v[52:53], v[32:33], v[186:187], v[52:53] op_sel:[1,0,0] op_sel_hi:[0,0,1] neg_hi:[1,0,0]
    v_pk_mul_f32 v[54:55], v[170:171], v[32:33] op_sel:[1,0] op_sel_hi:[1,1]
    v_pk_fma_f32 v[54:55], v[32:33], v[186:187], v[54:55] op_sel:[1,1,0] op_sel_hi:[0,1,1] neg_hi:[1,0,0]
    v_pk_mul_f32 v[170:171], v[52:53], v[110:111] op_sel_hi:[1,0]
    v_pk_mul_f32 v[186:187], v[110:111], v[54:55] op_sel:[1,0] op_sel_hi:[1,1]
    v_pk_mul_f32 v[52:53], v[172:173], v[32:33] op_sel:[0,0] op_sel_hi:[0,1]
    v_pk_fma_f32 v[52:53], v[32:33], v[188:189], v[52:53] op_sel:[1,0,0] op_sel_hi:[0,0,1] neg_hi:[1,0,0]
    v_pk_mul_f32 v[54:55], v[172:173], v[32:33] op_sel:[1,0] op_sel_hi:[1,1]
    v_pk_fma_f32 v[54:55], v[32:33], v[188:189], v[54:55] op_sel:[1,1,0] op_sel_hi:[0,1,1] neg_hi:[1,0,0]
    v_pk_mul_f32 v[172:173], v[52:53], v[112:113] op_sel_hi:[1,0]
    v_pk_mul_f32 v[188:189], v[112:113], v[54:55] op_sel:[1,0] op_sel_hi:[1,1]
    v_pk_mul_f32 v[52:53], v[174:175], v[32:33] op_sel:[0,0] op_sel_hi:[0,1]
    v_pk_fma_f32 v[52:53], v[32:33], v[190:191], v[52:53] op_sel:[1,0,0] op_sel_hi:[0,0,1] neg_hi:[1,0,0]
    v_pk_mul_f32 v[54:55], v[174:175], v[32:33] op_sel:[1,0] op_sel_hi:[1,1]
    v_pk_fma_f32 v[54:55], v[32:33], v[190:191], v[54:55] op_sel:[1,1,0] op_sel_hi:[0,1,1] neg_hi:[1,0,0]
    v_pk_mul_f32 v[174:175], v[52:53], v[114:115] op_sel_hi:[1,0]
    v_pk_mul_f32 v[190:191], v[114:115], v[54:55] op_sel:[1,0] op_sel_hi:[1,1]
    v_pk_fma_f32 v[58:59], v[20:21], v[160:161], v[176:177] op_sel_hi:[0,1,1]
    v_pk_fma_f32 v[56:57], v[20:21], v[160:161], v[58:59] op_sel:[1,1,0] op_sel_hi:[1,0,1] neg_lo:[1,0,0]
    v_pk_fma_f32 v[58:59], v[20:21], v[56:57], v[162:163] op_sel_hi:[0,1,1]
    v_pk_fma_f32 v[56:57], v[20:21], v[56:57], v[58:59] op_sel:[1,1,0] op_sel_hi:[1,0,1] neg_lo:[1,0,0]
    v_pk_fma_f32 v[58:59], v[20:21], v[56:57], v[178:179] op_sel_hi:[0,1,1]
    v_pk_fma_f32 v[56:57], v[20:21], v[56:57], v[58:59] op_sel:[1,1,0] op_sel_hi:[1,0,1] neg_lo:[1,0,0]
    v_pk_fma_f32 v[58:59], v[20:21], v[56:57], v[164:165] op_sel_hi:[0,1,1]
    v_pk_fma_f32 v[56:57], v[20:21], v[56:57], v[58:59] op_sel:[1,1,0] op_sel_hi:[1,0,1] neg_lo:[1,0,0]
    v_pk_fma_f32 v[58:59], v[20:21], v[56:57], v[180:181] op_sel_hi:[0,1,1]
    v_pk_fma_f32 v[56:57], v[20:21], v[56:57], v[58:59] op_sel:[1,1,0] op_sel_hi:[1,0,1] neg_lo:[1,0,0]
    v_pk_fma_f32 v[58:59], v[20:21], v[56:57], v[166:167] op_sel_hi:[0,1,1]
    v_pk_fma_f32 v[56:57], v[20:21], v[56:57], v[58:59] op_sel:[1,1,0] op_sel_hi:[1,0,1] neg_lo:[1,0,0]
    v_pk_fma_f32 v[58:59], v[20:21], v[56:57], v[182:183] op_sel_hi:[0,1,1]
    v_pk_fma_f32 v[56:57], v[20:21], v[56:57], v[58:59] op_sel:[1,1,0] op_sel_hi:[1,0,1] neg_lo:[1,0,0]
    v_pk_fma_f32 v[58:59], v[20:21], v[56:57], v[168:169] op_sel_hi:[0,1,1]
    v_pk_fma_f32 v[56:57], v[20:21], v[56:57], v[58:59] op_sel:[1,1,0] op_sel_hi:[1,0,1] neg_lo:[1,0,0]
    v_pk_fma_f32 v[58:59], v[20:21], v[56:57], v[184:185] op_sel_hi:[0,1,1]
    v_pk_fma_f32 v[56:57], v[20:21], v[56:57], v[58:59] op_sel:[1,1,0] op_sel_hi:[1,0,1] neg_lo:[1,0,0]
    v_pk_fma_f32 v[58:59], v[20:21], v[56:57], v[170:171] op_sel_hi:[0,1,1]
    v_pk_fma_f32 v[56:57], v[20:21], v[56:57], v[58:59] op_sel:[1,1,0] op_sel_hi:[1,0,1] neg_lo:[1,0,0]
    v_pk_fma_f32 v[58:59], v[20:21], v[56:57], v[186:187] op_sel_hi:[0,1,1]
    v_pk_fma_f32 v[56:57], v[20:21], v[56:57], v[58:59] op_sel:[1,1,0] op_sel_hi:[1,0,1] neg_lo:[1,0,0]
    v_pk_fma_f32 v[58:59], v[20:21], v[56:57], v[172:173] op_sel_hi:[0,1,1]
    v_pk_fma_f32 v[56:57], v[20:21], v[56:57], v[58:59] op_sel:[1,1,0] op_sel_hi:[1,0,1] neg_lo:[1,0,0]
    v_pk_fma_f32 v[58:59], v[20:21], v[56:57], v[188:189] op_sel_hi:[0,1,1]
    v_pk_fma_f32 v[56:57], v[20:21], v[56:57], v[58:59] op_sel:[1,1,0] op_sel_hi:[1,0,1] neg_lo:[1,0,0]
    v_pk_fma_f32 v[58:59], v[20:21], v[56:57], v[174:175] op_sel_hi:[0,1,1]
    v_pk_fma_f32 v[56:57], v[20:21], v[56:57], v[58:59] op_sel:[1,1,0] op_sel_hi:[1,0,1] neg_lo:[1,0,0]
    v_pk_fma_f32 v[58:59], v[20:21], v[56:57], v[190:191] op_sel_hi:[0,1,1]
    v_pk_fma_f32 v[56:57], v[20:21], v[56:57], v[58:59] op_sel:[1,1,0] op_sel_hi:[1,0,1] neg_lo:[1,0,0]
    v_mov_b32 v60, v56
    v_mov_b32 v62, v56
    v_mov_b32 v61, v57
    v_mov_b32 v63, v57
    v_permlane16_swap_b32 v60, v62
    s_nop 0
    v_permlane16_swap_b32 v61, v63
    v_mov_b32 v64, v60
    v_mov_b32 v66, v62
    v_mov_b32 v65, v61
    v_mov_b32_e64 v67, v63
    v_permlane32_swap_b32 v60, v64
    v_permlane32_swap_b32 v62, v66
    v_permlane32_swap_b32 v61, v65
    v_permlane32_swap_b32 v63, v67
    v_pk_fma_f32 v[58:59], v[22:23], v[60:61], v[62:63] op_sel_hi:[0,1,1]
    v_pk_fma_f32 v[62:63], v[22:23], v[60:61], v[58:59] op_sel:[1,1,0] op_sel_hi:[1,0,1] neg_lo:[1,0,0]
    v_pk_fma_f32 v[58:59], v[22:23], v[62:63], v[64:65] op_sel_hi:[0,1,1]
    v_pk_fma_f32 v[64:65], v[22:23], v[62:63], v[58:59] op_sel:[1,1,0] op_sel_hi:[1,0,1] neg_lo:[1,0,0]
    v_pk_fma_f32 v[58:59], v[22:23], v[64:65], v[66:67] op_sel_hi:[0,1,1]
    v_pk_fma_f32 v[72:73], v[22:23], v[64:65], v[58:59] op_sel:[1,1,0] op_sel_hi:[1,0,1] neg_lo:[1,0,0]
    s_cmp_eq_u32 s74, 0
    s_cbranch_scc0 L_nw_57
    ds_write_b64 v10, v[72:73] offset:3360
L_nw_57:
    s_mov_b64 exec, 0xffff
    v_mov_b32 v48, 0
    v_mov_b32 v49, 0
    s_lshl_b64 exec, exec, 16
    v_mov_b32 v48, v60
    v_mov_b32 v49, v61
    s_lshl_b64 exec, exec, 16
    v_mov_b32 v48, v62
    v_mov_b32 v49, v63
    s_lshl_b64 exec, exec, 16
    v_mov_b32 v48, v64
    v_mov_b32 v49, v65
    s_mov_b64 exec, -1
    v_pk_mul_f32 v[52:53], v[192:193], v[46:47] op_sel:[0,0] op_sel_hi:[0,1]
    v_pk_fma_f32 v[52:53], v[46:47], v[208:209], v[52:53] op_sel:[1,0,0] op_sel_hi:[0,0,1] neg_hi:[1,0,0]
    v_pk_mul_f32 v[54:55], v[192:193], v[46:47] op_sel:[1,0] op_sel_hi:[1,1]
    v_pk_fma_f32 v[54:55], v[46:47], v[208:209], v[54:55] op_sel:[1,1,0] op_sel_hi:[0,1,1] neg_hi:[1,0,0]
    v_pk_mul_f32 v[192:193], v[52:53], v[100:101] op_sel_hi:[1,0]
    v_pk_mul_f32 v[208:209], v[100:101], v[54:55] op_sel:[1,0] op_sel_hi:[1,1]
    v_pk_mul_f32 v[52:53], v[194:195], v[46:47] op_sel:[0,0] op_sel_hi:[0,1]
    v_pk_fma_f32 v[52:53], v[46:47], v[210:211], v[52:53] op_sel:[1,0,0] op_sel_hi:[0,0,1] neg_hi:[1,0,0]
    v_pk_mul_f32 v[54:55], v[194:195], v[46:47] op_sel:[1,0] op_sel_hi:[1,1]
    v_pk_fma_f32 v[54:55], v[46:47], v[210:211], v[54:55] op_sel:[1,1,0] op_sel_hi:[0,1,1] neg_hi:[1,0,0]
    v_pk_mul_f32 v[194:195], v[52:53], v[102:103] op_sel_hi:[1,0]
    v_pk_mul_f32 v[210:211], v[102:103], v[54:55] op_sel:[1,0] op_sel_hi:[1,1]
    v_pk_mul_f32 v[52:53], v[196:197], v[46:47] op_sel:[0,0] op_sel_hi:[0,1]
    v_pk_fma_f32 v[52:53], v[46:47], v[212:213], v[52:53] op_sel:[1,0,0] op_sel_hi:[0,0,1] neg_hi:[1,0,0]
    v_pk_mul_f32 v[54:55], v[196:197], v[46:47] op_sel:[1,0] op_sel_hi:[1,1]
    v_pk_fma_f32 v[54:55], v[46:47], v[212:213], v[54:55] op_sel:[1,1,0] op_sel_hi:[0,1,1] neg_hi:[1,0,0]
    v_pk_mul_f32 v[196:197], v[52:53], v[104:105] op_sel_hi:[1,0]
    v_pk_mul_f32 v[212:213], v[104:105], v[54:55] op_sel:[1,0] op_sel_hi:[1,1]
    v_pk_mul_f32 v[52:53], v[198:199], v[46:47] op_sel:[0,0] op_sel_hi:[0,1]
    v_pk_fma_f32 v[52:53], v[46:47], v[214:215], v[52:53] op_sel:[1,0,0] op_sel_hi:[0,0,1] neg_hi:[1,0,0]
    v_pk_mul_f32 v[54:55], v[198:199], v[46:47] op_sel:[1,0] op_sel_hi:[1,1]
    v_pk_fma_f32 v[54:55], v[46:47], v[214:215], v[54:55] op_sel:[1,1,0] op_sel_hi:[0,1,1] neg_hi:[1,0,0]
    v_pk_mul_f32 v[198:199], v[52:53], v[106:107] op_sel_hi:[1,0]
    v_pk_mul_f32 v[214:215], v[106:107], v[54:55] op_sel:[1,0] op_sel_hi:[1,1]
    v_pk_mul_f32 v[52:53], v[200:201], v[46:47] op_sel:[0,0] op_sel_hi:[0,1]
    v_pk_fma_f32 v[52:53], v[46:47], v[216:217], v[52:53] op_sel:[1,0,0] op_sel_hi:[0,0,1] neg_hi:[1,0,0]
    v_pk_mul_f32 v[54:55], v[200:201], v[46:47] op_sel:[1,0] op_sel_hi:[1,1]
    v_pk_fma_f32 v[54:55], v[46:47], v[216:217], v[54:55] op_sel:[1,1,0] op_sel_hi:[0,1,1] neg_hi:[1,0,0]
    v_pk_mul_f32 v[200:201], v[52:53], v[108:109] op_sel_hi:[1,0]
    v_pk_mul_f32 v[216:217], v[108:109], v[54:55] op_sel:[1,0] op_sel_hi:[1,1]
    v_pk_mul_f32 v[52:53], v[202:203], v[46:47] op_sel:[0,0] op_sel_hi:[0,1]
    v_pk_fma_f32 v[52:53], v[46:47], v[218:219], v[52:53] op_sel:[1,0,0] op_sel_hi:[0,0,1] neg_hi:[1,0,0]
    v_pk_mul_f32 v[54:55], v[202:203], v[46:47] op_sel:[1,0] op_sel_hi:[1,1]
    v_pk_fma_f32 v[54:55], v[46:47], v[218:219], v[54:55] op_sel:[1,1,0] op_sel_hi:[0,1,1] neg_hi:[1,0,0]
    v_pk_mul_f32 v[202:203], v[52:53], v[110:111] op_sel_hi:[1,0]
    v_pk_mul_f32 v[218:219], v[110:111], v[54:55] op_sel:[1,0] op_sel_hi:[1,1]
    v_pk_mul_f32 v[52:53], v[204:205], v[46:47] op_sel:[0,0] op_sel_hi:[0,1]
    v_pk_fma_f32 v[52:53], v[46:47], v[220:221], v[52:53] op_sel:[1,0,0] op_sel_hi:[0,0,1] neg_hi:[1,0,0]
    v_pk_mul_f32 v[54:55], v[204:205], v[46:47] op_sel:[1,0] op_sel_hi:[1,1]
    v_pk_fma_f32 v[54:55], v[46:47], v[220:221], v[54:55] op_sel:[1,1,0] op_sel_hi:[0,1,1] neg_hi:[1,0,0]
    v_pk_mul_f32 v[204:205], v[52:53], v[112:113] op_sel_hi:[1,0]
    v_pk_mul_f32 v[220:221], v[112:113], v[54:55] op_sel:[1,0] op_sel_hi:[1,1]
    v_pk_mul_f32 v[52:53], v[206:207], v[46:47] op_sel:[0,0] op_sel_hi:[0,1]
    v_pk_fma_f32 v[52:53], v[46:47], v[222:223], v[52:53] op_sel:[1,0,0] op_sel_hi:[0,0,1] neg_hi:[1,0,0]
    v_pk_mul_f32 v[54:55], v[206:207], v[46:47] op_sel:[1,0] op_sel_hi:[1,1]
    v_pk_fma_f32 v[54:55], v[46:47], v[222:223], v[54:55] op_sel:[1,1,0] op_sel_hi:[0,1,1] neg_hi:[1,0,0]
    v_pk_mul_f32 v[206:207], v[52:53], v[114:115] op_sel_hi:[1,0]
    v_pk_mul_f32 v[222:223], v[114:115], v[54:55] op_sel:[1,0] op_sel_hi:[1,1]
    v_pk_fma_f32 v[58:59], v[34:35], v[192:193], v[208:209] op_sel_hi:[0,1,1]
    v_pk_fma_f32 v[56:57], v[34:35], v[192:193], v[58:59] op_sel:[1,1,0] op_sel_hi:[1,0,1] neg_lo:[1,0,0]
    v_pk_fma_f32 v[58:59], v[34:35], v[56:57], v[194:195] op_sel_hi:[0,1,1]
    v_pk_fma_f32 v[56:57], v[34:35], v[56:57], v[58:59] op_sel:[1,1,0] op_sel_hi:[1,0,1] neg_lo:[1,0,0]
    v_pk_fma_f32 v[58:59], v[34:35], v[56:57], v[210:211] op_sel_hi:[0,1,1]
    v_pk_fma_f32 v[56:57], v[34:35], v[56:57], v[58:59] op_sel:[1,1,0] op_sel_hi:[1,0,1] neg_lo:[1,0,0]
    v_pk_fma_f32 v[58:59], v[34:35], v[56:57], v[196:197] op_sel_hi:[0,1,1]
    v_pk_fma_f32 v[56:57], v[34:35], v[56:57], v[58:59] op_sel:[1,1,0] op_sel_hi:[1,0,1] neg_lo:[1,0,0]
    v_pk_fma_f32 v[58:59], v[34:35], v[56:57], v[212:213] op_sel_hi:[0,1,1]
    v_pk_fma_f32 v[56:57], v[34:35], v[56:57], v[58:59] op_sel:[1,1,0] op_sel_hi:[1,0,1] neg_lo:[1,0,0]
    v_pk_fma_f32 v[58:59], v[34:35], v[56:57], v[198:199] op_sel_hi:[0,1,1]
    v_pk_fma_f32 v[56:57], v[34:35], v[56:57], v[58:59] op_sel:[1,1,0] op_sel_hi:[1,0,1] neg_lo:[1,0,0]
    v_pk_fma_f32 v[58:59], v[34:35], v[56:57], v[214:215] op_sel_hi:[0,1,1]
    v_pk_fma_f32 v[56:57], v[34:35], v[56:57], v[58:59] op_sel:[1,1,0] op_sel_hi:[1,0,1] neg_lo:[1,0,0]
    v_pk_fma_f32 v[58:59], v[34:35], v[56:57], v[200:201] op_sel_hi:[0,1,1]
    v_pk_fma_f32 v[56:57], v[34:35], v[56:57], v[58:59] op_sel:[1,1,0] op_sel_hi:[1,0,1] neg_lo:[1,0,0]
    v_pk_fma_f32 v[58:59], v[34:35], v[56:57], v[216:217] op_sel_hi:[0,1,1]
    v_pk_fma_f32 v[56:57], v[34:35], v[56:57], v[58:59] op_sel:[1,1,0] op_sel_hi:[1,0,1] neg_lo:[1,0,0]
    v_pk_fma_f32 v[58:59], v[34:35], v[56:57], v[202:203] op_sel_hi:[0,1,1]
    v_pk_fma_f32 v[56:57], v[34:35], v[56:57], v[58:59] op_sel:[1,1,0] op_sel_hi:[1,0,1] neg_lo:[1,0,0]
    v_pk_fma_f32 v[58:59], v[34:35], v[56:57], v[218:219] op_sel_hi:[0,1,1]
    v_pk_fma_f32 v[56:57], v[34:35], v[56:57], v[58:59] op_sel:[1,1,0] op_sel_hi:[1,0,1] neg_lo:[1,0,0]
    v_pk_fma_f32 v[58:59], v[34:35], v[56:57], v[204:205] op_sel_hi:[0,1,1]
    v_pk_fma_f32 v[56:57], v[34:35], v[56:57], v[58:59] op_sel:[1,1,0] op_sel_hi:[1,0,1] neg_lo:[1,0,0]
    v_pk_fma_f32 v[58:59], v[34:35], v[56:57], v[220:221] op_sel_hi:[0,1,1]
    v_pk_fma_f32 v[56:57], v[34:35], v[56:57], v[58:59] op_sel:[1,1,0] op_sel_hi:[1,0,1] neg_lo:[1,0,0]
    v_pk_fma_f32 v[58:59], v[34:35], v[56:57], v[206:207] op_sel_hi:[0,1,1]
    v_pk_fma_f32 v[56:57], v[34:35], v[56:57], v[58:59] op_sel:[1,1,0] op_sel_hi:[1,0,1] neg_lo:[1,0,0]
    v_pk_fma_f32 v[58:59], v[34:35], v[56:57], v[222:223] op_sel_hi:[0,1,1]
    v_pk_fma_f32 v[56:57], v[34:35], v[56:57], v[58:59] op_sel:[1,1,0] op_sel_hi:[1,0,1] neg_lo:[1,0,0]
    v_mov_b32 v60, v56
    v_mov_b32 v62, v56
    v_mov_b32 v61, v57
    v_mov_b32 v63, v57
    v_permlane16_swap_b32 v60, v62
    s_nop 0
    v_permlane16_swap_b32 v61, v63
    v_mov_b32 v64, v60
    v_mov_b32 v66, v62
    v_mov_b32 v65, v61
    v_mov_b32_e64 v67, v63
    v_permlane32_swap_b32 v60, v64
    v_permlane32_swap_b32 v62, v66
    v_permlane32_swap_b32 v61, v65
    v_permlane32_swap_b32 v63, v67
    v_pk_fma_f32 v[58:59], v[36:37], v[60:61], v[62:63] op_sel_hi:[0,1,1]
    v_pk_fma_f32 v[62:63], v[36:37], v[60:61], v[58:59] op_sel:[1,1,0] op_sel_hi:[1,0,1] neg_lo:[1,0,0]
    v_pk_fma_f32 v[58:59], v[36:37], v[62:63], v[64:65] op_sel_hi:[0,1,1]
    v_pk_fma_f32 v[64:65], v[36:37], v[62:63], v[58:59] op_sel:[1,1,0] op_sel_hi:[1,0,1] neg_lo:[1,0,0]
    v_pk_fma_f32 v[58:59], v[36:37], v[64:65], v[66:67] op_sel_hi:[0,1,1]
    v_pk_fma_f32 v[74:75], v[36:37], v[64:65], v[58:59] op_sel:[1,1,0] op_sel_hi:[1,0,1] neg_lo:[1,0,0]
    s_cmp_eq_u32 s74, 0
    s_cbranch_scc0 L_nw_58
    ds_write_b64 v10, v[74:75] offset:3488
L_nw_58:
    s_mov_b64 exec, 0xffff
    v_mov_b32 v50, 0
    v_mov_b32 v51, 0
    s_lshl_b64 exec, exec, 16
    v_mov_b32 v50, v60
    v_mov_b32 v51, v61
    s_lshl_b64 exec, exec, 16
    v_mov_b32 v50, v62
    v_mov_b32 v51, v63
    s_lshl_b64 exec, exec, 16
    v_mov_b32 v50, v64
    v_mov_b32 v51, v65
    s_mov_b64 exec, -1
    s_lshl2_add_u32 s4, s75, 81920
    v_mov_b32 v57, s4
    s_cmp_eq_u32 s74, 0
    s_cbranch_scc0 L_pb_59
    v_mov_b32 v56, 1
    ds_write_b32 v57, v56 offset:3088
    s_branch L_pe_60
L_pb_59:
    s_mov_b32 s38, 0
L_pt_61:
    ds_read_b32 v56, v57 offset:3088
    ds_read_b64 v[52:53], v10 offset:3360
    ds_read_b64 v[54:55], v10 offset:3488
    s_waitcnt lgkmcnt(0)
    v_cmp_gt_u32 vcc, 1, v56
    s_cbranch_vccz L_pt_61d
    s_add_u32 s38, s38, 1
    s_cmp_lt_u32 s38, 0x800000
    s_cbranch_scc0 L_pt_61d
    s_branch L_pt_61
L_pt_61d:
    v_pk_fma_f32 v[58:59], v[24:25], v[52:53], v[72:73] op_sel_hi:[0,1,1]
    v_pk_fma_f32 v[72:73], v[24:25], v[52:53], v[58:59] op_sel:[1,1,0] op_sel_hi:[1,0,1] neg_lo:[1,0,0]
    v_mov_b32 v60, v72
    v_mov_b32 v61, s51
    v_mov_b32 v62, v73
    v_mov_b32 v63, s51
    s_mov_b64 exec, 0xffff
    buffer_store_dwordx4 v[60:63], v17, s[56:59], 0 offen offset:0 sc1
    s_mov_b64 exec, -1
    v_pk_fma_f32 v[58:59], v[38:39], v[54:55], v[74:75] op_sel_hi:[0,1,1]
    v_pk_fma_f32 v[74:75], v[38:39], v[54:55], v[58:59] op_sel:[1,1,0] op_sel_hi:[1,0,1] neg_lo:[1,0,0]
    v_mov_b32 v64, v74
    v_mov_b32 v65, s51
    v_mov_b32 v66, v75
    v_mov_b32_e64 v67, s51
    s_mov_b64 exec, 0xffff
    buffer_store_dwordx4 v[64:67], v17, s[56:59], 0 offen offset:512 sc1
    s_mov_b64 exec, -1
L_pe_60:
    v_mfma_f32_16x16x16_bf16 v[232:235], v[96:97], v[84:85], v[232:235]
    v_max_f32 v224, 0, v224
    v_max_f32_e64 v225, 0, v225
    v_mfma_f32_16x16x16_bf16 v[248:251], v[98:99], v[84:85], v[248:251]
    v_max_f32 v226, 0, v226
    v_max_f32 v227, 0, v227
    v_pk_mul_f32 v[224:225], v[120:121], v[224:225] op_sel:[0,0] op_sel_hi:[0,1]
    v_pk_mul_f32 v[226:227], v[120:121], v[226:227] op_sel:[0,0] op_sel_hi:[0,1]
    v_pk_mul_f32 v[224:225], v[224:225], v[224:225]
    v_pk_mul_f32 v[226:227], v[226:227], v[226:227]
    v_cvt_pk_bf16_f32 v132, v224, v225
    v_cvt_pk_bf16_f32 v133, v226, v227
    v_mfma_f32_16x16x16_bf16 v[236:239], v[96:97], v[86:87], v[236:239]
    v_max_f32 v240, 0, v240
    v_max_f32 v241, 0, v241
    v_mfma_f32_16x16x16_bf16 v[252:255], v[98:99], v[86:87], v[252:255]
    v_max_f32 v242, 0, v242
    v_max_f32 v243, 0, v243
    v_pk_mul_f32 v[240:241], v[120:121], v[240:241] op_sel:[0,0] op_sel_hi:[0,1]
    v_pk_mul_f32 v[242:243], v[120:121], v[242:243] op_sel:[0,0] op_sel_hi:[0,1]
    v_pk_mul_f32 v[240:241], v[240:241], v[240:241]
    v_pk_mul_f32 v[242:243], v[242:243], v[242:243]
    v_cvt_pk_bf16_f32 v134, v240, v241
    v_cvt_pk_bf16_f32 v135, v242, v243
    buffer_store_dwordx4 v[132:135], v12, s[56:59], s62 offen sc1
    s_add_u32 s62, s62, 49152
    v_max_f32 v228, 0, v228
    v_max_f32 v229, 0, v229
    v_max_f32 v230, 0, v230
    v_max_f32 v231, 0, v231
    v_pk_mul_f32 v[228:229], v[120:121], v[228:229] op_sel:[1,0] op_sel_hi:[1,1]
    v_pk_mul_f32 v[230:231], v[120:121], v[230:231] op_sel:[1,0] op_sel_hi:[1,1]
    v_pk_mul_f32 v[228:229], v[228:229], v[228:229]
    v_pk_mul_f32 v[230:231], v[230:231], v[230:231]
    v_cvt_pk_bf16_f32 v136, v228, v229
    v_cvt_pk_bf16_f32 v137, v230, v231
    v_max_f32 v244, 0, v244
    v_max_f32 v245, 0, v245
    v_max_f32 v246, 0, v246
    v_max_f32 v247, 0, v247
    v_pk_mul_f32 v[244:245], v[120:121], v[244:245] op_sel:[1,0] op_sel_hi:[1,1]
    v_pk_mul_f32 v[246:247], v[120:121], v[246:247] op_sel:[1,0] op_sel_hi:[1,1]
    v_pk_mul_f32 v[244:245], v[244:245], v[244:245]
    v_pk_mul_f32 v[246:247], v[246:247], v[246:247]
    v_cvt_pk_bf16_f32 v138, v244, v245
    v_cvt_pk_bf16_f32 v139, v246, v247
    buffer_store_dwordx4 v[136:139], v12, s[56:59], s62 offen sc1
    s_add_u32 s62, s62, 49152
    v_max_f32 v232, 0, v232
    v_max_f32 v233, 0, v233
    v_max_f32 v234, 0, v234
    v_max_f32 v235, 0, v235
    v_pk_mul_f32 v[232:233], v[122:123], v[232:233] op_sel:[0,0] op_sel_hi:[0,1]
    v_pk_mul_f32 v[234:235], v[122:123], v[234:235] op_sel:[0,0] op_sel_hi:[0,1]
    v_pk_mul_f32 v[232:233], v[232:233], v[232:233]
    v_pk_mul_f32 v[234:235], v[234:235], v[234:235]
    v_cvt_pk_bf16_f32 v140, v232, v233
    v_cvt_pk_bf16_f32 v141, v234, v235
    v_max_f32 v248, 0, v248
    v_max_f32 v249, 0, v249
    v_max_f32 v250, 0, v250
    v_max_f32 v251, 0, v251
    v_pk_mul_f32 v[248:249], v[122:123], v[248:249] op_sel:[0,0] op_sel_hi:[0,1]
    v_pk_mul_f32 v[250:251], v[122:123], v[250:251] op_sel:[0,0] op_sel_hi:[0,1]
    v_pk_mul_f32 v[248:249], v[248:249], v[248:249]
    v_pk_mul_f32 v[250:251], v[250:251], v[250:251]
    v_cvt_pk_bf16_f32 v142, v248, v249
    v_cvt_pk_bf16_f32 v143, v250, v251
    buffer_store_dwordx4 v[140:143], v12, s[56:59], s62 offen sc1
    s_add_u32 s62, s62, 49152
    v_max_f32 v236, 0, v236
    v_max_f32 v237, 0, v237
    v_max_f32 v238, 0, v238
    v_max_f32 v239, 0, v239
    v_pk_mul_f32 v[236:237], v[122:123], v[236:237] op_sel:[1,0] op_sel_hi:[1,1]
    v_pk_mul_f32 v[238:239], v[122:123], v[238:239] op_sel:[1,0] op_sel_hi:[1,1]
    v_pk_mul_f32 v[236:237], v[236:237], v[236:237]
    v_pk_mul_f32 v[238:239], v[238:239], v[238:239]
    v_cvt_pk_bf16_f32 v144, v236, v237
    v_cvt_pk_bf16_f32 v145, v238, v239
    v_max_f32 v252, 0, v252
    v_max_f32 v253, 0, v253
    v_max_f32 v254, 0, v254
    v_max_f32 v255, 0, v255
    v_pk_mul_f32 v[252:253], v[122:123], v[252:253] op_sel:[1,0] op_sel_hi:[1,1]
    v_pk_mul_f32 v[254:255], v[122:123], v[254:255] op_sel:[1,0] op_sel_hi:[1,1]
    v_pk_mul_f32 v[252:253], v[252:253], v[252:253]
    v_pk_mul_f32 v[254:255], v[254:255], v[254:255]
    v_cvt_pk_bf16_f32 v146, v252, v253
    v_cvt_pk_bf16_f32 v147, v254, v255
    buffer_store_dwordx4 v[144:147], v12, s[56:59], s62 offen sc1
    s_add_u32 s62, s62, 49152
    s_barrier
    v_mul_u32_u24 v120, 40960, v2
    v_sub_u32 v120, v17, v120
    v_subrev_u32 v123, 40960, v120
    v_subrev_u32 v122, 30720, v120
    v_subrev_u32 v121, 20480, v120
    v_subrev_u32 v120, 10240, v120
    v_ashrrev_i32_e64 v124, 31, v120
    v_bfi_b32 v124, v124, 0, s51
    v_ashrrev_i32_e64 v125, 31, v121
    v_bfi_b32 v125, v125, 0, s51
    v_ashrrev_i32_e64 v126, 31, v122
    v_bfi_b32 v126, v126, 0, s51
    v_ashrrev_i32_e64 v127, 31, v123
    v_bfi_b32 v127, v127, 0, s51
    s_mov_b32 s38, 0
    s_waitcnt vmcnt(0)
    s_mov_b64 exec, 1
    v_mov_b32 v76, 81920
    v_mov_b32 v77, 1
    ds_add_rtn_u32 v77, v76, v77 offset:3104
    s_mov_b64 exec, -1
    s_waitcnt lgkmcnt(0)
    v_readfirstlane_b32 s4, v77
    s_cmp_eq_u32 s4, 3
    s_cbranch_scc0 L_arr_65
    s_mov_b32 exec_hi, 0
    s_mov_b32 s4, 0
    s_nop 0
    buffer_store_dword v19, v18, s[56:59], s4 offen sc1
    s_mov_b32 exec_hi, -1
L_arr_65:
    buffer_load_dwordx4 v[80:83], v120, s[56:59], 0 offen offset:0 sc1
    buffer_load_dwordx4 v[84:87], v121, s[56:59], 0 offen offset:0 sc1
    buffer_load_dwordx4 v[88:91], v122, s[56:59], 0 offen offset:0 sc1
    buffer_load_dwordx4 v[92:95], v123, s[56:59], 0 offen offset:0 sc1
    buffer_load_dwordx4 v[96:99], v120, s[56:59], 0 offen offset:512 sc1
    buffer_load_dwordx4 v[100:103], v121, s[56:59], 0 offen offset:512 sc1
    buffer_load_dwordx4 v[104:107], v122, s[56:59], 0 offen offset:512 sc1
    buffer_load_dwordx4 v[108:111], v123, s[56:59], 0 offen offset:512 sc1
    s_branch L_lbc_64
L_lb_62:
    buffer_load_dwordx4 v[80:83], v120, s[56:59], 0 offen offset:0 sc1
    buffer_load_dwordx4 v[84:87], v121, s[56:59], 0 offen offset:0 sc1
    buffer_load_dwordx4 v[88:91], v122, s[56:59], 0 offen offset:0 sc1
    buffer_load_dwordx4 v[92:95], v123, s[56:59], 0 offen offset:0 sc1
    buffer_load_dwordx4 v[96:99], v120, s[56:59], 0 offen offset:512 sc1
    buffer_load_dwordx4 v[100:103], v121, s[56:59], 0 offen offset:512 sc1
    buffer_load_dwordx4 v[104:107], v122, s[56:59], 0 offen offset:512 sc1
    buffer_load_dwordx4 v[108:111], v123, s[56:59], 0 offen offset:512 sc1
L_lbc_64:
    s_waitcnt vmcnt(0)
    v_xor_b32 v81, v81, v124
    v_xor_b32 v83, v83, v124
    v_or_b32 v58, v81, v83
    v_xor_b32 v85, v85, v125
    v_xor_b32 v87, v87, v125
    v_or3_b32 v58, v58, v85, v87
    v_xor_b32 v89, v89, v126
    v_xor_b32 v91, v91, v126
    v_or3_b32 v58, v58, v89, v91
    v_xor_b32 v93, v93, v127
    v_xor_b32 v95, v95, v127
    v_or3_b32 v58, v58, v93, v95
    v_xor_b32 v97, v97, v124
    v_xor_b32 v99, v99, v124
    v_or3_b32 v58, v58, v97, v99
    v_xor_b32 v101, v101, v125
    v_xor_b32 v103, v103, v125
    v_or3_b32 v58, v58, v101, v103
    v_xor_b32 v105, v105, v126
    v_xor_b32 v107, v107, v126
    v_or3_b32 v58, v58, v105, v107
    v_xor_b32 v109, v109, v127
    v_xor_b32 v111, v111, v127
    v_or3_b32 v58, v58, v109, v111
    v_cmp_ne_u32 vcc, 0, v58
    s_cbranch_vccz L_lbd_63
    s_add_u32 s38, s38, 1
    s_cmp_lt_u32 s38, 0x40000
    s_cbranch_scc0 L_lbd_63
    s_sleep 4
    s_branch L_lb_62
L_lbd_63:
    v_mov_b32 v81, v82
    v_mov_b32 v85, v86
    v_mov_b32 v89, v90
    v_mov_b32 v93, v94
    v_fmac_f32 v88, v26, v92
    v_fmac_f32 v89, v26, v93
    v_fma_f32 v88, -v27, v93, v88
    v_fmac_f32 v89, v27, v92
    v_fmac_f32 v84, v26, v88
    v_fmac_f32_e64 v85, v26, v89
    v_fma_f32 v84, -v27, v89, v84
    v_fmac_f32 v85, v27, v88
    v_fmac_f32 v80, v26, v84
    v_fmac_f32_e64 v81, v26, v85
    v_fma_f32 v80, -v27, v85, v80
    v_fmac_f32 v81, v27, v84
    v_mul_f32 v56, v30, v80
    v_mul_f32_e64 v57, v30, v81
    v_fma_f32 v56, -v31, v81, v56
    v_fmac_f32 v57, v31, v80
    v_mov_b32 v58, v56
    v_mov_b32 v59, v57
    s_nop 0
    v_permlane16_swap_b32 v56, v58
    v_permlane16_swap_b32 v57, v59
    v_add_f32 v56, v56, v58
    v_add_f32 v57, v57, v59
    v_mov_b32 v58, v56
    v_mov_b32 v59, v57
    s_nop 0
    v_permlane32_swap_b32 v56, v58
    v_permlane32_swap_b32 v57, v59
    v_add_f32 v56, v56, v58
    v_add_f32 v57, v57, v59
    s_cmp_eq_u32 s74, 0
    s_cbranch_scc1 L_w0_66
    v_fmac_f32 v52, v24, v56
    v_fmac_f32_e64 v53, v24, v57
    v_fma_f32 v52, -v25, v57, v52
    v_fmac_f32 v53, v25, v56
    v_mov_b32 v56, v52
    v_mov_b32 v57, v53
L_w0_66:
    v_fmac_f32 v48, v28, v56
    v_fmac_f32_e64 v49, v28, v57
    v_fma_f32 v48, -v29, v57, v48
    v_fmac_f32 v49, v29, v56
    v_fmac_f32 v160, v20, v48
    v_fmac_f32_e64 v161, v20, v49
    v_fma_f32 v160, -v21, v49, v160
    v_fmac_f32 v161, v21, v48
    v_fmac_f32 v176, v20, v160
    v_fmac_f32_e64 v177, v20, v161
    v_fma_f32 v176, -v21, v161, v176
    v_fmac_f32 v177, v21, v160
    v_fmac_f32 v162, v20, v176
    v_fmac_f32_e64 v163, v20, v177
    v_fma_f32 v162, -v21, v177, v162
    v_fmac_f32 v163, v21, v176
    v_fmac_f32 v178, v20, v162
    v_fmac_f32_e64 v179, v20, v163
    v_fma_f32 v178, -v21, v163, v178
    v_fmac_f32 v179, v21, v162
    v_fmac_f32 v164, v20, v178
    v_fmac_f32_e64 v165, v20, v179
    v_fma_f32 v164, -v21, v179, v164
    v_fmac_f32 v165, v21, v178
    v_fmac_f32 v180, v20, v164
    v_fmac_f32_e64 v181, v20, v165
    v_fma_f32 v180, -v21, v165, v180
    v_fmac_f32 v181, v21, v164
    v_fmac_f32 v166, v20, v180
    v_fmac_f32_e64 v167, v20, v181
    v_fma_f32 v166, -v21, v181, v166
    v_fmac_f32 v167, v21, v180
    v_fmac_f32 v182, v20, v166
    v_fmac_f32_e64 v183, v20, v167
    v_fma_f32 v182, -v21, v167, v182
    v_fmac_f32 v183, v21, v166
    v_fmac_f32 v168, v20, v182
    v_fmac_f32_e64 v169, v20, v183
    v_fma_f32 v168, -v21, v183, v168
    v_fmac_f32 v169, v21, v182
    v_fmac_f32 v184, v20, v168
    v_fmac_f32_e64 v185, v20, v169
    v_fma_f32 v184, -v21, v169, v184
    v_fmac_f32 v185, v21, v168
    v_fmac_f32 v170, v20, v184
    v_fmac_f32_e64 v171, v20, v185
    v_fma_f32 v170, -v21, v185, v170
    v_fmac_f32 v171, v21, v184
    v_fmac_f32 v186, v20, v170
    v_fmac_f32_e64 v187, v20, v171
    v_fma_f32 v186, -v21, v171, v186
    v_fmac_f32 v187, v21, v170
    v_fmac_f32 v172, v20, v186
    v_fmac_f32_e64 v173, v20, v187
    v_fma_f32 v172, -v21, v187, v172
    v_fmac_f32 v173, v21, v186
    v_fmac_f32 v188, v20, v172
    v_fmac_f32_e64 v189, v20, v173
    v_fma_f32 v188, -v21, v173, v188
    v_fmac_f32 v189, v21, v172
    v_fmac_f32 v174, v20, v188
    v_fmac_f32_e64 v175, v20, v189
    v_fma_f32 v174, -v21, v189, v174
    v_fmac_f32 v175, v21, v188
    v_fmac_f32 v190, v20, v174
    v_fmac_f32_e64 v191, v20, v175
    v_fma_f32 v190, -v21, v175, v190
    v_fmac_f32_e64 v191, v21, v174
    v_cvt_pk_bf16_f32 v128, v160, v176
    v_cvt_pk_bf16_f32 v129, v162, v178
    v_cvt_pk_bf16_f32 v130, v164, v180
    v_cvt_pk_bf16_f32 v131, v166, v182
    ds_write_b128 v14, v[128:131] offset:0
    v_cvt_pk_bf16_f32 v132, v168, v184
    v_cvt_pk_bf16_f32 v133, v170, v186
    v_cvt_pk_bf16_f32 v134, v172, v188
    v_cvt_pk_bf16_f32 v135, v174, v190
    ds_write_b128 v14, v[132:135] offset:1024
    v_cvt_pk_bf16_f32 v136, v161, v177
    v_cvt_pk_bf16_f32 v137, v163, v179
    v_cvt_pk_bf16_f32 v138, v165, v181
    v_cvt_pk_bf16_f32 v139, v167, v183
    ds_write_b128 v14, v[136:139] offset:2048
    v_cvt_pk_bf16_f32 v140, v169, v185
    v_cvt_pk_bf16_f32 v141, v171, v187
    v_cvt_pk_bf16_f32 v142, v173, v189
    v_cvt_pk_bf16_f32 v143, v175, v191
    ds_write_b128 v14, v[140:143] offset:3072
    ds_read_b64_tr_b16 v[144:145], v15 offset:0
    ds_read_b64_tr_b16 v[146:147], v16 offset:0
    ds_read_b64_tr_b16 v[148:149], v15 offset:8
    ds_read_b64_tr_b16 v[150:151], v16 offset:8
    ds_read_b64_tr_b16 v[152:153], v15 offset:1024
    ds_read_b64_tr_b16 v[154:155], v16 offset:1024
    ds_read_b64_tr_b16 v[156:157], v15 offset:1032
    ds_read_b64_tr_b16 v[158:159], v16 offset:1032
    s_mul_i32 s5, s53, 10
    s_sub_u32 s4, s45, s5
    s_add_u32 s4, s4, 0
    s_and_b32 s5, s4, -2
    s_add_u32 s4, s4, s5
    s_add_u32 s4, s4, 28
    s_lshl_b32 s4, s4, 10
    s_add_u32 s4, s4, s39
    s_waitcnt lgkmcnt(6)
    buffer_store_dwordx4 v[144:147], v13, s[56:59], s4 offen sc1
    s_add_u32 s4, s4, 49152
    s_waitcnt lgkmcnt(4)
    buffer_store_dwordx4 v[148:151], v13, s[56:59], s4 offen sc1
    s_add_u32 s4, s4, 49152
    s_waitcnt lgkmcnt(2)
    buffer_store_dwordx4 v[152:155], v13, s[56:59], s4 offen sc1
    s_add_u32 s4, s4, 49152
    s_waitcnt lgkmcnt(0)
    buffer_store_dwordx4 v[156:159], v13, s[56:59], s4 offen sc1
    s_add_u32 s4, s4, 49152
    v_mov_b32 v97, v98
    v_mov_b32 v101, v102
    v_mov_b32 v105, v106
    v_mov_b32 v109, v110
    v_fmac_f32 v104, v40, v108
    v_fmac_f32 v105, v40, v109
    v_fma_f32 v104, -v41, v109, v104
    v_fmac_f32 v105, v41, v108
    v_fmac_f32 v100, v40, v104
    v_fmac_f32_e64 v101, v40, v105
    v_fma_f32 v100, -v41, v105, v100
    v_fmac_f32 v101, v41, v104
    v_fmac_f32 v96, v40, v100
    v_fmac_f32_e64 v97, v40, v101
    v_fma_f32 v96, -v41, v101, v96
    v_fmac_f32 v97, v41, v100
    v_mul_f32 v56, v44, v96
    v_mul_f32_e64 v57, v44, v97
    v_fma_f32 v56, -v45, v97, v56
    v_fmac_f32 v57, v45, v96
    v_mov_b32 v58, v56
    v_mov_b32 v59, v57
    s_nop 0
    v_permlane16_swap_b32 v56, v58
    v_permlane16_swap_b32 v57, v59
    v_add_f32 v56, v56, v58
    v_add_f32 v57, v57, v59
    v_mov_b32 v58, v56
    v_mov_b32 v59, v57
    s_nop 0
    v_permlane32_swap_b32 v56, v58
    v_permlane32_swap_b32 v57, v59
    v_add_f32 v56, v56, v58
    v_add_f32 v57, v57, v59
    s_cmp_eq_u32 s74, 0
    s_cbranch_scc1 L_w0_67
    v_fmac_f32 v54, v38, v56
    v_fmac_f32_e64 v55, v38, v57
    v_fma_f32 v54, -v39, v57, v54
    v_fmac_f32 v55, v39, v56
    v_mov_b32 v56, v54
    v_mov_b32 v57, v55
L_w0_67:
    v_fmac_f32 v50, v42, v56
    v_fmac_f32_e64 v51, v42, v57
    v_fma_f32 v50, -v43, v57, v50
    v_fmac_f32 v51, v43, v56
    v_fmac_f32 v192, v34, v50
    v_fmac_f32_e64 v193, v34, v51
    v_fma_f32 v192, -v35, v51, v192
    v_fmac_f32 v193, v35, v50
    v_fmac_f32 v208, v34, v192
    v_fmac_f32_e64 v209, v34, v193
    v_fma_f32 v208, -v35, v193, v208
    v_fmac_f32 v209, v35, v192
    v_fmac_f32 v194, v34, v208
    v_fmac_f32_e64 v195, v34, v209
    v_fma_f32 v194, -v35, v209, v194
    v_fmac_f32 v195, v35, v208
    v_fmac_f32 v210, v34, v194
    v_fmac_f32_e64 v211, v34, v195
    v_fma_f32 v210, -v35, v195, v210
    v_fmac_f32 v211, v35, v194
    v_fmac_f32 v196, v34, v210
    v_fmac_f32_e64 v197, v34, v211
    v_fma_f32 v196, -v35, v211, v196
    v_fmac_f32 v197, v35, v210
    v_fmac_f32 v212, v34, v196
    v_fmac_f32_e64 v213, v34, v197
    v_fma_f32 v212, -v35, v197, v212
    v_fmac_f32 v213, v35, v196
    v_fmac_f32 v198, v34, v212
    v_fmac_f32_e64 v199, v34, v213
    v_fma_f32 v198, -v35, v213, v198
    v_fmac_f32 v199, v35, v212
    v_fmac_f32 v214, v34, v198
    v_fmac_f32_e64 v215, v34, v199
    v_fma_f32 v214, -v35, v199, v214
    v_fmac_f32 v215, v35, v198
    v_fmac_f32 v200, v34, v214
    v_fmac_f32_e64 v201, v34, v215
    v_fma_f32 v200, -v35, v215, v200
    v_fmac_f32 v201, v35, v214
    v_fmac_f32 v216, v34, v200
    v_fmac_f32_e64 v217, v34, v201
    v_fma_f32 v216, -v35, v201, v216
    v_fmac_f32 v217, v35, v200
    v_fmac_f32 v202, v34, v216
    v_fmac_f32_e64 v203, v34, v217
    v_fma_f32 v202, -v35, v217, v202
    v_fmac_f32 v203, v35, v216
    v_fmac_f32 v218, v34, v202
    v_fmac_f32_e64 v219, v34, v203
    v_fma_f32 v218, -v35, v203, v218
    v_fmac_f32 v219, v35, v202
    v_fmac_f32 v204, v34, v218
    v_fmac_f32_e64 v205, v34, v219
    v_fma_f32 v204, -v35, v219, v204
    v_fmac_f32 v205, v35, v218
    v_fmac_f32 v220, v34, v204
    v_fmac_f32_e64 v221, v34, v205
    v_fma_f32 v220, -v35, v205, v220
    v_fmac_f32 v221, v35, v204
    v_fmac_f32 v206, v34, v220
    v_fmac_f32_e64 v207, v34, v221
    v_fma_f32 v206, -v35, v221, v206
    v_fmac_f32 v207, v35, v220
    v_fmac_f32 v222, v34, v206
    v_fmac_f32_e64 v223, v34, v207
    v_fma_f32 v222, -v35, v207, v222
    v_fmac_f32_e64 v223, v35, v206
    v_cvt_pk_bf16_f32 v128, v192, v208
    v_cvt_pk_bf16_f32 v129, v194, v210
    v_cvt_pk_bf16_f32 v130, v196, v212
    v_cvt_pk_bf16_f32 v131, v198, v214
    ds_write_b128 v14, v[128:131] offset:0
    v_cvt_pk_bf16_f32 v132, v200, v216
    v_cvt_pk_bf16_f32 v133, v202, v218
    v_cvt_pk_bf16_f32 v134, v204, v220
    v_cvt_pk_bf16_f32 v135, v206, v222
    ds_write_b128 v14, v[132:135] offset:1024
    v_cvt_pk_bf16_f32 v136, v193, v209
    v_cvt_pk_bf16_f32 v137, v195, v211
    v_cvt_pk_bf16_f32 v138, v197, v213
    v_cvt_pk_bf16_f32 v139, v199, v215
    ds_write_b128 v14, v[136:139] offset:2048
    v_cvt_pk_bf16_f32 v140, v201, v217
    v_cvt_pk_bf16_f32 v141, v203, v219
    v_cvt_pk_bf16_f32 v142, v205, v221
    v_cvt_pk_bf16_f32 v143, v207, v223
    ds_write_b128 v14, v[140:143] offset:3072
    ds_read_b64_tr_b16 v[144:145], v15 offset:0
    ds_read_b64_tr_b16 v[146:147], v16 offset:0
    ds_read_b64_tr_b16 v[148:149], v15 offset:8
    ds_read_b64_tr_b16 v[150:151], v16 offset:8
    ds_read_b64_tr_b16 v[152:153], v15 offset:1024
    ds_read_b64_tr_b16 v[154:155], v16 offset:1024
    ds_read_b64_tr_b16 v[156:157], v15 offset:1032
    ds_read_b64_tr_b16 v[158:159], v16 offset:1032
    s_mul_i32 s5, s53, 10
    s_sub_u32 s4, s45, s5
    s_add_u32 s4, s4, 1
    s_and_b32 s5, s4, -2
    s_add_u32 s4, s4, s5
    s_add_u32 s4, s4, 28
    s_lshl_b32 s4, s4, 10
    s_add_u32 s4, s4, s39
    s_waitcnt lgkmcnt(6)
    buffer_store_dwordx4 v[144:147], v13, s[56:59], s4 offen sc1
    s_add_u32 s4, s4, 49152
    s_waitcnt lgkmcnt(4)
    buffer_store_dwordx4 v[148:151], v13, s[56:59], s4 offen sc1
    s_add_u32 s4, s4, 49152
    s_waitcnt lgkmcnt(2)
    buffer_store_dwordx4 v[152:155], v13, s[56:59], s4 offen sc1
    s_add_u32 s4, s4, 49152
    s_waitcnt lgkmcnt(0)
    buffer_store_dwordx4 v[156:159], v13, s[56:59], s4 offen sc1
    s_add_u32 s4, s4, 49152
    s_branch L_ctail
L_ctail:
    v_lshrrev_b32 v44, 3, v0
    v_and_b32 v45, 7, v0
    v_xor_b32 v45, v45, v2
    v_mul_u32_u24 v44, 1280, v44
    v_lshl_add_u32 v20, v45, 4, v44
    v_xor_b32_e64 v44, 64, v20
    v_add_u32 v21, 10240, v44
    s_cmp_ge_u32 s52, 2
    s_cselect_b64 vcc, -1, 0
    v_cndmask_b32 v22, v20, v21, vcc
    s_mul_i32 s14, s52, 5120
    s_lshl1_add_u32 s6, s42, s53
    s_lshl_b32 s6, s6, 6
    s_lshl2_add_u32 s6, s52, s6
    s_lshl_b32 s7, s49, 4
    s_add_u32 s5, s14, 40960
    s_lshl2_add_u32 s4, s53, s52
    s_lshl_b32 s4, s4, 7
    s_add_u32 s15, s4, 81920
    s_mov_b32 s38, 81920
    v_mov_b32 v44, v1
    v_add_u32_e64 v45, 0, v2
    v_lshl_add_u32 v46, v45, 3, s15
    ds_read_b32 v190, v46 offset:4
    v_lshl_add_u32 v47, v44, 3, s38
    ds_read_b64 v[170:171], v47 offset:3200
    ds_read_b64 v[180:181], v47 offset:3872
    v_add_u32 v48, v44, v45
    v_and_b32 v48, 15, v48
    v_lshl_add_u32 v48, v44, 4, v48
    v_lshl_add_u32 v30, v48, 4, s5
    v_and_b32 v48, 12, v45
    v_and_b32 v49, 3, v45
    v_lshl_add_u32 v48, v48, 2, v49
    v_add_u32 v48, s6, v48
    v_add_u32 v44, s7, v44
    v_mul_u32_u24 v48, 1280, v48
    v_lshl_add_u32 v35, v44, 3, v48
    v_lshlrev_b32 v25, 1, v35
    v_mov_b32 v44, v1
    v_add_u32_e64 v45, 4, v2
    v_lshl_add_u32 v46, v45, 3, s15
    ds_read_b32 v191, v46 offset:4
    v_lshl_add_u32 v47, v44, 3, s38
    ds_read_b64 v[172:173], v47 offset:3200
    ds_read_b64 v[182:183], v47 offset:3872
    v_add_u32 v48, v44, v45
    v_and_b32 v48, 15, v48
    v_lshl_add_u32 v48, v44, 4, v48
    v_lshl_add_u32 v31, v48, 4, s5
    v_and_b32 v48, 12, v45
    v_and_b32 v49, 3, v45
    v_lshl_add_u32 v48, v48, 2, v49
    v_add_u32 v48, s6, v48
    v_add_u32 v44, s7, v44
    v_mul_u32_u24 v48, 1280, v48
    v_lshl_add_u32 v36, v44, 3, v48
    v_lshlrev_b32_e64 v26, 1, v36
    s_waitcnt vmcnt(0)
    s_mov_b64 exec, 1
    v_mov_b32 v76, 81920
    v_mov_b32_e64 v77, 1
    ds_add_rtn_u32 v77, v76, v77 offset:3108
    s_mov_b64 exec, -1
    v_mov_b32 v44, v1
    v_add_u32_e64 v45, 8, v2
    v_lshl_add_u32 v46, v45, 3, s15
    ds_read_b32 v192, v46 offset:4
    v_lshl_add_u32 v47, v44, 3, s38
    ds_read_b64 v[174:175], v47 offset:3200
    ds_read_b64 v[184:185], v47 offset:3872
    v_add_u32 v48, v44, v45
    v_and_b32 v48, 15, v48
    v_lshl_add_u32 v48, v44, 4, v48
    v_lshl_add_u32 v32, v48, 4, s5
    v_and_b32 v48, 12, v45
    v_and_b32 v49, 3, v45
    v_lshl_add_u32 v48, v48, 2, v49
    v_add_u32 v48, s6, v48
    v_add_u32 v44, s7, v44
    v_mul_u32_u24 v48, 1280, v48
    v_lshl_add_u32 v37, v44, 3, v48
    v_lshlrev_b32 v27, 1, v37
    s_waitcnt lgkmcnt(0)
    v_readfirstlane_b32 s4, v77
    s_cmp_eq_u32 s4, 3
    s_cbranch_scc0 L_arr_68
    s_mov_b32 exec_hi, 0
    s_mov_b32 s4, 65536
    s_nop 0
    buffer_store_dword v19, v18, s[56:59], s4 offen sc1
    s_mov_b32 exec_hi, -1
L_arr_68:
    v_mov_b32 v44, v1
    v_add_u32 v45, 12, v2
    v_lshl_add_u32 v46, v45, 3, s15
    ds_read_b32 v193, v46 offset:4
    v_lshl_add_u32 v47, v44, 3, s38
    ds_read_b64 v[176:177], v47 offset:3200
    ds_read_b64 v[186:187], v47 offset:3872
    v_add_u32 v48, v44, v45
    v_and_b32 v48, 15, v48
    v_lshl_add_u32 v48, v44, 4, v48
    v_lshl_add_u32 v33, v48, 4, s5
    v_and_b32 v48, 12, v45
    v_and_b32 v49, 3, v45
    v_lshl_add_u32 v48, v48, 2, v49
    v_add_u32 v48, s6, v48
    v_add_u32 v44, s7, v44
    v_mul_u32_u24 v48, 1280, v48
    v_lshl_add_u32 v38, v44, 3, v48
    v_lshlrev_b32 v28, 1, v38
    v_and_b32 v44, 3, v0
    v_add_u32 v44, 16, v44
    v_lshrrev_b32 v45, 2, v0
    s_lshl2_add_u32 s7, s49, 112
    v_lshl_add_u32 v46, v45, 3, s15
    ds_read_b32 v194, v46 offset:4
    v_lshl_add_u32 v47, v44, 3, s38
    ds_read_b64 v[178:179], v47 offset:3200
    ds_read_b64 v[188:189], v47 offset:3872
    v_add_u32 v48, v44, v45
    v_and_b32 v48, 15, v48
    v_lshl_add_u32 v48, v44, 4, v48
    v_lshl_add_u32 v34, v48, 4, s5
    v_and_b32 v48, 12, v45
    v_and_b32 v49, 3, v45
    v_lshl_add_u32 v48, v48, 2, v49
    v_add_u32 v48, s6, v48
    v_add_u32 v44, s7, v44
    v_mul_u32_u24 v48, 1280, v48
    v_lshl_add_u32 v39, v44, 3, v48
    v_lshlrev_b32 v29, 1, v39
    v_and_b32 v44, 3, v0
    v_lshl_add_u32 v40, v44, 2, s38
    s_lshl2_add_u32 s4, s52, 81920
    v_mov_b32_e64 v41, s4
    s_mov_b32 s60, s8
    s_mov_b32 s61, s9
    s_mov_b32 s62, 0x280000
    s_mov_b32 s63, 0x20000
    s_mov_b32 s80, s36
    s_mov_b32 s81, s37
    s_mov_b32 s82, 0x500000
    s_mov_b32 s83, 0x20000
    s_and_b32 s4, s52, 1
    s_cselect_b64 s[76:77], s[20:21], s[18:19]
    s_mov_b32 s78, 0xc8000
    s_mov_b32 s79, 0x20000
    buffer_load_dwordx2 v[160:161], v35, s[60:63], 0 offen
    buffer_load_dwordx2 v[162:163], v36, s[60:63], 0 offen
    buffer_load_dwordx2 v[164:165], v37, s[60:63], 0 offen
    buffer_load_dwordx2 v[166:167], v38, s[60:63], 0 offen
    buffer_load_dwordx2 v[168:169], v39, s[60:63], 0 offen
    s_mul_i32 s26, s52, 10240
    s_mul_i32 s4, s53, 640
    s_mul_i32 s6, s49, 81920
    s_add_u32 s16, s4, s6
    s_mul_i32 s6, s49, 20480
    s_add_u32 s4, s4, s6
    s_add_u32 s8, s4, 655360
    s_lshl_b32 s4, s74, 7
    s_add_u32 s32, s4, s16
    s_add_u32 s10, s4, s8
    s_mul_i32 s4, s74, 40960
    s_add_u32 s9, s4, s16
    s_mul_i32 s33, s75, 10240
    s_mov_b32 s38, 0
L_lw_69:
    ds_read_b32 v42, v40 offset:3072
    s_waitcnt lgkmcnt(0)
    v_cmp_gt_u32 vcc, 2, v42
    s_cbranch_vccz L_lw_69d
    s_add_u32 s38, s38, 1
    s_cmp_lt_u32 s38, 0x400000
    s_cbranch_scc0 L_lw_69d
    s_sleep 1
    s_branch L_lw_69
L_lw_69d:
    s_lshl_b32 s4, s74, 12
    s_add_u32 s4, s4, s33
    s_add_u32 m0, s4, 102400
    s_add_u32 s5, s9, 0
    buffer_load_dwordx4 v20, s[76:79], s5 offen lds
    s_add_u32 m0, s4, 103424
    s_add_u32 s5, s9, 0
    buffer_load_dwordx4 v21, s[76:79], s5 offen lds
    s_add_u32 m0, s4, 104448
    s_add_u32 s5, s9, 20480
    buffer_load_dwordx4 v20, s[76:79], s5 offen lds
    s_add_u32 m0, s4, 105472
    s_add_u32 s5, s9, 20480
    buffer_load_dwordx4 v21, s[76:79], s5 offen lds
    s_lshl_b32 s4, s74, 10
    s_add_u32 s4, s4, s33
    s_add_u32 m0, s4, 110592
    s_nop 0
    buffer_load_dwordx4 v22, s[76:79], s8 offen lds
    s_waitcnt vmcnt(5)
    v_lshlrev_b32_e64 v44, 16, v190
    v_and_b32 v45, 0xffff0000, v190
    v_rcp_f32 v45, v45
    v_lshlrev_b32 v46, 16, v160
    v_lshlrev_b32 v47, 16, v170
    v_lshlrev_b32 v200, 16, v180
    v_add_f32 v200, v200, v46
    v_add_f32 v46, v46, v44
    v_mul_f32 v47, v47, v45
    v_fmac_f32 v200, v46, v47
    v_and_b32 v46, 0xffff0000, v160
    v_and_b32 v47, 0xffff0000, v170
    v_and_b32 v201, 0xffff0000, v180
    v_add_f32 v201, v201, v46
    v_add_f32 v46, v46, v44
    v_mul_f32 v47, v47, v45
    v_fmac_f32 v201, v46, v47
    v_lshlrev_b32 v46, 16, v161
    v_lshlrev_b32 v47, 16, v171
    v_lshlrev_b32 v202, 16, v181
    v_add_f32 v202, v202, v46
    v_add_f32 v46, v46, v44
    v_mul_f32 v47, v47, v45
    v_fmac_f32_e64 v202, v46, v47
    v_and_b32 v46, 0xffff0000, v161
    v_and_b32 v47, 0xffff0000, v171
    v_and_b32 v203, 0xffff0000, v181
    v_add_f32 v203, v203, v46
    v_add_f32 v46, v46, v44
    v_mul_f32 v47, v47, v45
    v_fmac_f32 v203, v46, v47
    v_lshlrev_b32_e64 v44, 16, v191
    v_and_b32 v45, 0xffff0000, v191
    v_rcp_f32 v45, v45
    v_lshlrev_b32 v46, 16, v162
    v_lshlrev_b32 v47, 16, v172
    v_lshlrev_b32 v204, 16, v182
    v_add_f32 v204, v204, v46
    v_add_f32 v46, v46, v44
    v_mul_f32 v47, v47, v45
    v_fmac_f32 v204, v46, v47
    v_and_b32 v46, 0xffff0000, v162
    v_and_b32 v47, 0xffff0000, v172
    v_and_b32 v205, 0xffff0000, v182
    v_add_f32 v205, v205, v46
    v_add_f32 v46, v46, v44
    v_mul_f32 v47, v47, v45
    v_fmac_f32 v205, v46, v47
    v_lshlrev_b32 v46, 16, v163
    v_lshlrev_b32 v47, 16, v173
    v_lshlrev_b32 v206, 16, v183
    v_add_f32 v206, v206, v46
    v_add_f32 v46, v46, v44
    v_mul_f32 v47, v47, v45
    v_fmac_f32_e64 v206, v46, v47
    v_and_b32 v46, 0xffff0000, v163
    v_and_b32 v47, 0xffff0000, v173
    v_and_b32 v207, 0xffff0000, v183
    v_add_f32 v207, v207, v46
    v_add_f32 v46, v46, v44
    v_mul_f32 v47, v47, v45
    v_fmac_f32_e64 v207, v46, v47
    s_mov_b32 s38, 0
L_lw_70:
    ds_read_b32 v42, v40 offset:3072
    s_waitcnt lgkmcnt(0)
    v_cmp_gt_u32 vcc, 4, v42
    s_cbranch_vccz L_lw_70d
    s_add_u32 s38, s38, 1
    s_cmp_lt_u32 s38, 0x400000
    s_cbranch_scc0 L_lw_70d
    s_sleep 1
    s_branch L_lw_70
L_lw_70d:
    s_add_u32 m0, s26, 122880
    s_add_u32 s5, s32, 128
    buffer_load_dwordx4 v20, s[76:79], s5 offen lds
    s_add_u32 m0, s26, 123904
    s_add_u32 s5, s32, 128
    buffer_load_dwordx4 v21, s[76:79], s5 offen lds
    s_add_u32 m0, s26, 124928
    s_add_u32 s5, s32, 20608
    buffer_load_dwordx4 v20, s[76:79], s5 offen lds
    s_add_u32 m0, s26, 125952
    s_add_u32 s5, s32, 20608
    buffer_load_dwordx4 v21, s[76:79], s5 offen lds
    s_add_u32 m0, s26, 126976
    s_add_u32 s5, s32, 41088
    buffer_load_dwordx4 v20, s[76:79], s5 offen lds
    s_add_u32 m0, s26, 128000
    s_add_u32 s5, s32, 41088
    buffer_load_dwordx4 v21, s[76:79], s5 offen lds
    s_add_u32 m0, s26, 129024
    s_add_u32 s5, s32, 61568
    buffer_load_dwordx4 v20, s[76:79], s5 offen lds
    s_add_u32 m0, s26, 130048
    s_add_u32 s5, s32, 61568
    buffer_load_dwordx4 v21, s[76:79], s5 offen lds
    s_add_u32 m0, s26, 131072
    s_add_u32 s5, s10, 128
    buffer_load_dwordx4 v20, s[76:79], s5 offen lds
    s_add_u32 m0, s26, 132096
    s_add_u32 s5, s10, 128
    buffer_load_dwordx4 v21, s[76:79], s5 offen lds
    s_lshl2_add_u32 s4, s50, s52
    s_lshl_b32 s4, s4, 8
    s_add_u32 s4, s4, 0x68000
    s_add_u32 s6, s40, s4
    s_addc_u32 s7, s41, 0
    s_mov_b32 s38, 0
L_pfs:
    s_load_dword s64, s[6:7], 0 glc
    s_load_dword s65, s[6:7], 128 glc
L_pfsc:
    s_waitcnt lgkmcnt(0)
    s_xor_b32 s64, s64, s51
    s_xor_b32 s65, s65, s51
    s_or_b32 s64, s64, s65
    s_cbranch_scc0 L_pfsd
    s_add_u32 s38, s38, 1
    s_cmp_lt_u32 s38, 0x40000
    s_cbranch_scc0 L_pfsd
    s_sleep 1
    s_branch L_pfs
L_pfsd:
    v_mov_b32 v42, 1
    ds_write_b32 v41, v42 offset:3120
    v_mov_b32 v42, 1
    s_waitcnt vmcnt(0)
    ds_write_b32 v41, v42 offset:3136
    v_lshlrev_b32_e64 v44, 16, v192
    v_and_b32 v45, 0xffff0000, v192
    v_rcp_f32 v45, v45
    v_lshlrev_b32 v46, 16, v164
    v_lshlrev_b32 v47, 16, v174
    v_lshlrev_b32 v208, 16, v184
    v_add_f32 v208, v208, v46
    v_add_f32 v46, v46, v44
    v_mul_f32 v47, v47, v45
    v_fmac_f32 v208, v46, v47
    v_and_b32 v46, 0xffff0000, v164
    v_and_b32 v47, 0xffff0000, v174
    v_and_b32 v209, 0xffff0000, v184
    v_add_f32 v209, v209, v46
    v_add_f32 v46, v46, v44
    v_mul_f32 v47, v47, v45
    v_fmac_f32 v209, v46, v47
    v_lshlrev_b32 v46, 16, v165
    v_lshlrev_b32 v47, 16, v175
    v_lshlrev_b32 v210, 16, v185
    v_add_f32 v210, v210, v46
    v_add_f32 v46, v46, v44
    v_mul_f32 v47, v47, v45
    v_fmac_f32_e64 v210, v46, v47
    v_and_b32 v46, 0xffff0000, v165
    v_and_b32 v47, 0xffff0000, v175
    v_and_b32 v211, 0xffff0000, v185
    v_add_f32 v211, v211, v46
    v_add_f32 v46, v46, v44
    v_mul_f32 v47, v47, v45
    v_fmac_f32 v211, v46, v47
    v_lshlrev_b32_e64 v44, 16, v193
    v_and_b32 v45, 0xffff0000, v193
    v_rcp_f32 v45, v45
    v_lshlrev_b32 v46, 16, v166
    v_lshlrev_b32 v47, 16, v176
    v_lshlrev_b32 v212, 16, v186
    v_add_f32 v212, v212, v46
    v_add_f32 v46, v46, v44
    v_mul_f32 v47, v47, v45
    v_fmac_f32 v212, v46, v47
    v_and_b32 v46, 0xffff0000, v166
    v_and_b32 v47, 0xffff0000, v176
    v_and_b32 v213, 0xffff0000, v186
    v_add_f32 v213, v213, v46
    v_add_f32 v46, v46, v44
    v_mul_f32 v47, v47, v45
    v_fmac_f32 v213, v46, v47
    v_lshlrev_b32 v46, 16, v167
    v_lshlrev_b32 v47, 16, v177
    v_lshlrev_b32 v214, 16, v187
    v_add_f32 v214, v214, v46
    v_add_f32 v46, v46, v44
    v_mul_f32 v47, v47, v45
    v_fmac_f32_e64 v214, v46, v47
    v_and_b32 v46, 0xffff0000, v167
    v_and_b32 v47, 0xffff0000, v177
    v_and_b32 v215, 0xffff0000, v187
    v_add_f32 v215, v215, v46
    v_add_f32 v46, v46, v44
    v_mul_f32 v47, v47, v45
    v_fmac_f32 v215, v46, v47
    v_lshlrev_b32_e64 v44, 16, v194
    v_and_b32 v45, 0xffff0000, v194
    v_rcp_f32 v45, v45
    v_lshlrev_b32 v46, 16, v168
    v_lshlrev_b32 v47, 16, v178
    v_lshlrev_b32 v216, 16, v188
    v_add_f32 v216, v216, v46
    v_add_f32 v46, v46, v44
    v_mul_f32 v47, v47, v45
    v_fmac_f32 v216, v46, v47
    v_and_b32 v46, 0xffff0000, v168
    v_and_b32 v47, 0xffff0000, v178
    v_and_b32 v217, 0xffff0000, v188
    v_add_f32 v217, v217, v46
    v_add_f32 v46, v46, v44
    v_mul_f32 v47, v47, v45
    v_fmac_f32 v217, v46, v47
    v_lshlrev_b32 v46, 16, v169
    v_lshlrev_b32 v47, 16, v179
    v_lshlrev_b32 v218, 16, v189
    v_add_f32 v218, v218, v46
    v_add_f32 v46, v46, v44
    v_mul_f32 v47, v47, v45
    v_fmac_f32_e64 v218, v46, v47
    v_and_b32 v46, 0xffff0000, v169
    v_and_b32 v47, 0xffff0000, v179
    v_and_b32 v219, 0xffff0000, v189
    v_add_f32 v219, v219, v46
    v_add_f32 v46, v46, v44
    v_mul_f32 v47, v47, v45
    v_fmac_f32_e64 v219, v46, v47
    s_mov_b32 s38, 0
L_lw_71:
    ds_read_b32 v42, v40 offset:3072
    s_waitcnt lgkmcnt(0)
    v_cmp_gt_u32 vcc, 5, v42
    s_cbranch_vccz L_lw_71d
    s_add_u32 s38, s38, 1
    s_cmp_lt_u32 s38, 0x400000
    s_cbranch_scc0 L_lw_71d
    s_sleep 1
    s_branch L_lw_71
L_lw_71d:
    s_add_u32 m0, s26, 0
    s_add_u32 s5, s32, 384
    buffer_load_dwordx4 v20, s[76:79], s5 offen lds
    s_add_u32 m0, s26, 1024
    s_add_u32 s5, s32, 384
    buffer_load_dwordx4 v21, s[76:79], s5 offen lds
    s_add_u32 m0, s26, 2048
    s_add_u32 s5, s32, 20864
    buffer_load_dwordx4 v20, s[76:79], s5 offen lds
    s_add_u32 m0, s26, 3072
    s_add_u32 s5, s32, 20864
    buffer_load_dwordx4 v21, s[76:79], s5 offen lds
    s_add_u32 m0, s26, 4096
    s_add_u32 s5, s32, 41344
    buffer_load_dwordx4 v20, s[76:79], s5 offen lds
    s_add_u32 m0, s26, 5120
    s_add_u32 s5, s32, 41344
    buffer_load_dwordx4 v21, s[76:79], s5 offen lds
    s_add_u32 m0, s26, 6144
    s_add_u32 s5, s32, 61824
    buffer_load_dwordx4 v20, s[76:79], s5 offen lds
    s_add_u32 m0, s26, 7168
    s_add_u32 s5, s32, 61824
    buffer_load_dwordx4 v21, s[76:79], s5 offen lds
    s_add_u32 m0, s26, 8192
    s_add_u32 s5, s10, 384
    buffer_load_dwordx4 v20, s[76:79], s5 offen lds
    s_add_u32 m0, s26, 9216
    s_add_u32 s5, s10, 384
    buffer_load_dwordx4 v21, s[76:79], s5 offen lds
    s_lshl3_add_u32 s4, s50, s49
    s_mul_i32 s5, s52, 3072
    s_add_u32 s5, s5, 0xce8000
    s_mul_i32 s6, s4, 12288
    s_add_u32 s17, s6, s5
    v_mov_b32 v42, 2
    s_waitcnt vmcnt(0)
    ds_write_b32 v41, v42 offset:3136
    s_add_u32 s4, s17, 3068
    s_add_u32 s6, s40, s4
    s_addc_u32 s7, s41, 0
    s_mov_b32 s38, 0
L_xw_72:
    s_load_dword s64, s[6:7], 0 glc
L_xw_72c:
    s_waitcnt lgkmcnt(0)
    s_xor_b32 s64, s64, s51
    s_cbranch_scc0 L_xw_72d
    s_add_u32 s38, s38, 1
    s_cmp_lt_u32 s38, 0x40000
    s_cbranch_scc0 L_xw_72d
    s_sleep 1
    s_branch L_xw_72
L_xw_72d:
    v_mov_b32_e64 v42, 1
    ds_write_b32 v41, v42 offset:3152
    s_mov_b32 s38, 0
L_lw_73:
    ds_read_b32 v42, v41 offset:3072
    s_waitcnt lgkmcnt(0)
    v_cmp_gt_u32 vcc, 8, v42
    s_cbranch_vccz L_lw_73d
    s_add_u32 s38, s38, 1
    s_cmp_lt_u32 s38, 0x400000
    s_cbranch_scc0 L_lw_73d
    s_branch L_lw_73
L_lw_73d:
    ds_read_b128 v[80:83], v30 offset:20480
    ds_read_b128 v[84:87], v31 offset:20480
    ds_read_b128 v[88:91], v32 offset:20480
    ds_read_b128 v[92:95], v33 offset:20480
    ds_read_b128 v[96:99], v34 offset:20480
    s_waitcnt lgkmcnt(4)
    v_pk_add_f32 v[200:201], v[200:201], v[80:81]
    v_pk_add_f32 v[202:203], v[202:203], v[82:83]
    buffer_store_dwordx4 v[200:203], v25, s[80:83], 0 offen sc1
    s_waitcnt lgkmcnt(3)
    v_pk_add_f32 v[204:205], v[204:205], v[84:85]
    v_pk_add_f32 v[206:207], v[206:207], v[86:87]
    buffer_store_dwordx4 v[204:207], v26, s[80:83], 0 offen sc1
    s_waitcnt lgkmcnt(2)
    v_pk_add_f32 v[208:209], v[208:209], v[88:89]
    v_pk_add_f32 v[210:211], v[210:211], v[90:91]
    buffer_store_dwordx4 v[208:211], v27, s[80:83], 0 offen sc1
    s_waitcnt lgkmcnt(1)
    v_pk_add_f32 v[212:213], v[212:213], v[92:93]
    v_pk_add_f32 v[214:215], v[214:215], v[94:95]
    buffer_store_dwordx4 v[212:215], v28, s[80:83], 0 offen sc1
    s_waitcnt lgkmcnt(0)
    v_pk_add_f32 v[216:217], v[216:217], v[96:97]
    v_pk_add_f32 v[218:219], v[218:219], v[98:99]
    buffer_store_dwordx4 v[216:219], v29, s[80:83], 0 offen sc1
    s_cmp_eq_u32 s50, 30
    s_cbranch_scc0 L_noep
    s_add_u32 s4, s49, s52
    s_cmp_eq_u32 s4, 0
    s_cbranch_scc0 L_noep
    v_mov_b32 v44, 0x70000
    s_mov_b64 exec, 1
    buffer_store_dword v19, v44, s[56:59], 0 offen sc1
    s_mov_b64 exec, -1
L_noep:
L_exit:
    s_endpgm
L_codeend:
.section .rodata,"a"
.p2align 6
.amdhsa_kernel parallel_sum__ssm_conv_s5__dense_activation_squared_relu__prompt_kernel
  .amdhsa_next_free_vgpr 256
  .amdhsa_next_free_sgpr 102
  .amdhsa_accum_offset 256
  .amdhsa_group_segment_fixed_size 0
  .amdhsa_kernarg_size 136
  .amdhsa_user_sgpr_count 2
  .amdhsa_user_sgpr_kernarg_segment_ptr 1
  .amdhsa_system_sgpr_workgroup_id_x 1
.end_amdhsa_kernel
```
